```python
import torch

def _softmax(x, axis=-1):
    return torch.softmax(x, dim=axis)
def _gelu(x):
    return torch.nn.functional.gelu(x, approximate="tanh")
def _silu(x):
    return torch.nn.functional.silu(x)
def _sigmoid(x):
    return torch.sigmoid(x)
def _layernorm(x, axis=-1, eps=1e-5):
    m = x.mean(dim=axis, keepdim=True)
    v = x.var(dim=axis, keepdim=True, unbiased=False)
    return (x - m) / torch.sqrt(v + eps)
def _scatter_add(tgt, idx, src, axis=0):
    return tgt.clone().index_add_(axis, idx, src)
def _segment_sum(src, seg, n):
    out = torch.zeros((n,) + src.shape[1:], dtype=src.dtype)
    return out.index_add_(0, seg, src)
def _pad(x, pw):
    flat = tuple(v for pair in reversed(pw) for v in pair)
    return torch.nn.functional.pad(x, flat)

kernel_name = 'gated_mix__ssm_conv_s4d__mha_block__prompt'

def setup_inputs():

    _w = (lambda a: (lambda t: t.to(torch.bfloat16) if t.is_floating_point() else t)(torch.as_tensor(a)))
    def _A_setup():
        Bsz, L, D, N = 1, 2048, 576, 128
        return {
            "u": _w((lambda *s: torch.randn(*s, dtype=torch.bfloat16) * 0.05)(Bsz, L, D)),
            "log_A_real": _w((lambda *s: torch.randn(*s, dtype=torch.bfloat16) * 6.4)(D, N) * 0.5),
            "A_imag": _w((lambda *s: torch.randn(*s, dtype=torch.bfloat16) * 0.1)(D, N) * 3.14),
            "C_real": _w((lambda *s: torch.randn(*s, dtype=torch.bfloat16) * 0.4)(D, N) / N ** 0.5),
            "C_imag": _w((lambda *s: torch.randn(*s, dtype=torch.bfloat16) * 0.4)(D, N) / N ** 0.5),
            "log_dt": _w((lambda *s: torch.randn(*s, dtype=torch.bfloat16) * 0.1)(D) * 0.5 - 4.0),
            "D_skip": _w((lambda *s: torch.randn(*s, dtype=torch.bfloat16) * 0.1)(D)),
        }
    _A_in = _A_setup()

    def _B_setup():
        B, S, D, H = 1, 2048, 576, 32
        return {
            "x": _w((lambda *s: torch.randn(*s, dtype=torch.bfloat16) * 0.05)(B, S, D)),
            "wqkv": _w((lambda *s: torch.randn(*s, dtype=torch.bfloat16) * 0.8)(D, 3 * D)),
            "wo": _w((lambda *s: torch.randn(*s, dtype=torch.bfloat16) * 0.05)(D, D)),
        }
    _B_in = _B_setup()

    return {
        "A_u": _A_in["u"],
        "A_log_A_real": _A_in["log_A_real"],
        "A_A_imag": _A_in["A_imag"],
        "A_C_real": _A_in["C_real"],
        "A_C_imag": _A_in["C_imag"],
        "A_log_dt": _A_in["log_dt"],
        "A_D_skip": _A_in["D_skip"],
        "B_x": _B_in["x"],
        "B_wqkv": _B_in["wqkv"],
        "B_wo": _B_in["wo"],
        "gate_w": _w((lambda *s: torch.randn(*s, dtype=torch.bfloat16) * 0.05)(576) * 16.0),
    }

def reference(A_u, A_log_A_real, A_A_imag, A_C_real, A_C_imag, A_log_dt, A_D_skip, B_x, B_wqkv, B_wo, gate_w):
    def _A_ref(u, log_A_real, A_imag, C_real, C_imag, log_dt, D_skip):
        L = u.shape[1]
        dt = torch.exp(log_dt)
        A = -torch.exp(log_A_real) + 1j * A_imag
        C = (C_real + 1j * C_imag) * dt[:, None]
        pos = (lambda x, dt: x.to(dt))(torch.arange(L), log_dt.dtype)
        P = torch.exp((A * dt[:, None])[:, :, None] * pos[None, None, :])
        K = 2.0 * torch.einsum("dn,dnl->dl", C, P).real
        L2 = 2 * L
        u_t = (lambda x, *d: x.permute(*d))(u, 0, 2, 1)
        Kf = (lambda x, *a, **k: torch.fft.rfft(x.float(), *a, **k))(K, L2)
        Uf = (lambda x, *a, **k: torch.fft.rfft(x.float(), *a, **k))(u_t, L2)
        y = (lambda x, *a, **k: torch.fft.irfft(x, *a, **k).to(torch.bfloat16))(Uf * Kf[None, :, :], L2)[:, :, :L]
        y = (lambda x, *d: x.permute(*d))(y, 0, 2, 1)
        return y + u * D_skip[None, None, :]

    def _B_ref(x, wqkv, wo):
        B, S, D = x.shape
        H = 32
        Dh = D // H
        qkv = (lambda x, *d: x.permute(*d))((x @ wqkv).reshape(B, S, 3, H, Dh), 2, 0, 3, 1, 4)
        q, k, v = qkv[0], qkv[1], qkv[2]
        scores = torch.einsum("bhqd,bhkd->bhqk", q, k) * (Dh ** -0.5)
        p = _softmax(scores, axis=-1)
        o = torch.einsum("bhqk,bhkd->bhqd", p, v)
        return (lambda x, *d: x.permute(*d))(o, 0, 2, 1, 3).reshape(B, S, D) @ wo

    x = A_u
    g = _sigmoid((x * gate_w).sum(-1, keepdims=True))
    a = _A_ref(x, A_log_A_real, A_A_imag, A_C_real, A_C_imag, A_log_dt, A_D_skip)
    b = _B_ref(x, B_wqkv, B_wo)
    return g * a + (1 - g) * b
```

```asm
; @launch grid=(256,1,1) block=(768,1,1) lds=163840
.amdgcn_target "amdgcn-amd-amdhsa--gfx950"
.text
.globl gated_mix__ssm_conv_s4d__mha_block__prompt_kernel
.p2align 8
.type gated_mix__ssm_conv_s4d__mha_block__prompt_kernel,@function
gated_mix__ssm_conv_s4d__mha_block__prompt_kernel:
    s_cmp_ge_u32 s2, 256
    s_cbranch_scc1 F_END
    s_load_dwordx2 s[8:9], s[0:1], 0
    s_load_dwordx2 s[12:13], s[0:1], 64
    s_load_dwordx2 s[16:17], s[0:1], 104
    s_load_dwordx16 s[32:47], s[0:1], 0
    s_load_dwordx8 s[48:55], s[0:1], 64
    s_load_dwordx4 s[56:59], s[0:1], 96
    v_lshrrev_b32 v1, 6, v0
    v_and_b32 v0, 63, v0
    v_readfirstlane_b32 s3, v1
    v_mov_b32 v2, 0
    s_cmp_lt_u32 s3, 4
    s_cselect_b32 s27, 8, -4
    s_cmp_ge_u32 s2, 224
    s_cselect_b32 s27, s27, 0
    s_add_u32 s3, s3, s27
    v_mov_b32 v3, 163584
    v_lshl_add_u32 v4, v0, 2, v3
    ds_write_b32 v4, v2
    v_mov_b32 v1, 1
    v_and_b32 v4, 31, v0
    v_lshrrev_b32 v5, 5, v0
    s_bfe_u32 s6, s2, 0x20003
    s_lshr_b32 s7, s2, 5
    s_and_b32 s4, s2, 3
    s_lshl_b32 s4, s4, 2
    s_add_u32 s4, s4, s6
    s_bfe_u32 s5, s2, 0x10002
    s_mul_i32 s5, s5, 7
    s_add_u32 s5, s5, s7
    s_mov_b32 s18, 15380480
    s_mov_b32 s19, 0x20000
    s_cmp_eq_u32 s5, 13
    s_cselect_b32 s27, 7, 15
    v_lshrrev_b32 v7, 4, v0
    v_lshlrev_b32 v8, 2, v7
    v_sub_u32 v8, v0, v8
    v_and_b32 v8, s27, v8
    v_mul_u32_u24 v7, 3456, v7
    v_lshl_add_u32 v6, v8, 4, v7
    v_lshrrev_b32 v9, 3, v0
    v_and_b32 v10, 7, v0
    v_lshrrev_b32 v11, 1, v9
    v_xor_b32 v10, v10, v11
    v_mul_u32_u24 v9, 1152, v9
    v_lshl_add_u32 v7, v10, 4, v9
    v_xor_b32 v10, 4, v10
    v_lshl_add_u32 v8, v10, 4, v9
    v_add_u32 v8, 8192, v8
    v_add_u32 v9, 12800, v6
    s_lshl_b32 s22, s5, 8
    s_mul_i32 s27, s3, 55296
    s_add_u32 s22, s22, s27
    s_lshl_b32 s23, s4, 2
    s_add_u32 s23, s23, s3
    s_mul_i32 s23, s23, 36864
    s_lshl_b32 s24, s3, 12
    s_lshl_b32 s20, s6, 1
    s_add_u32 s20, s20, s7
    s_sub_u32 s27, s20, 9
    s_cmp_ge_u32 s20, 9
    s_cselect_b32 s20, s27, s20
    s_add_u32 s20, s6, s7
    s_mov_b32 s21, s20
    s_sub_u32 s27, s20, 4
    s_cmp_ge_u32 s20, 4
    s_cselect_b32 s20, s27, s20
    s_sub_u32 s27, s20, 4
    s_cmp_ge_u32 s20, 4
    s_cselect_b32 s20, s27, s20
    s_sub_u32 s27, s21, 5
    s_cmp_ge_u32 s21, 5
    s_cselect_b32 s21, s27, s21
    s_add_u32 s21, s21, 4
    s_and_b32 s31, s2, 7
    s_mul_i32 s31, s31, 36
    s_lshr_b32 s27, s2, 3
    s_add_u32 s31, s31, s27
    s_max_u32 s27, s27, 28
    s_add_u32 s31, s31, s27
    s_sub_u32 s31, s31, 28
    s_cmp_ge_u32 s2, 224
    s_cselect_b32 s27, 4, s3
    s_cmp_ge_u32 s27, 4
    s_waitcnt lgkmcnt(0)
    s_cbranch_scc1 F_OTHER
    s_or_b32 s27, s2, s3
    s_cbranch_scc0 F_NONCE
F_NN:
    s_add_u32 s12, s12, s22
    s_addc_u32 s13, s13, 0
    s_add_u32 s8, s8, s23
    s_addc_u32 s9, s9, 0
    s_mul_i32 s25, s20, 221184
    s_lshl_b32 s26, s20, 7
    s_add_u32 s14, s12, s25
    s_addc_u32 s15, s13, 0
    s_add_u32 s10, s8, s26
    s_addc_u32 s11, s9, 0
    s_add_u32 m0, s24, 0
    s_add_u32 s20, s20, 1
    global_load_lds_dwordx4 v6, s[14:15]
    global_load_lds_dwordx4 v9, s[14:15] offset:1024
    s_add_u32 m0, m0, 16384
    s_cmp_eq_u32 s20, 4
    s_cselect_b32 s20, 0, s20
    global_load_lds_dwordx4 v7, s[10:11]
    global_load_lds_dwordx4 v8, s[10:11] offset:1024
    s_add_u32 m0, s24, 2048
    s_add_u32 s14, s14, 27648
    s_addc_u32 s15, s15, 0
    global_load_lds_dwordx4 v6, s[14:15]
    global_load_lds_dwordx4 v9, s[14:15] offset:1024
    s_add_u32 m0, m0, 16384
    s_add_u32 s10, s10, 18432
    s_addc_u32 s11, s11, 0
    global_load_lds_dwordx4 v7, s[10:11]
    global_load_lds_dwordx4 v8, s[10:11] offset:1024
    s_mul_i32 s25, s20, 221184
    s_lshl_b32 s26, s20, 7
    s_add_u32 s14, s12, s25
    s_addc_u32 s15, s13, 0
    s_add_u32 s10, s8, s26
    s_addc_u32 s11, s9, 0
    s_add_u32 m0, s24, 32768
    s_add_u32 s20, s20, 1
    global_load_lds_dwordx4 v6, s[14:15]
    global_load_lds_dwordx4 v9, s[14:15] offset:1024
    s_add_u32 m0, m0, 16384
    s_cmp_eq_u32 s20, 4
    s_cselect_b32 s20, 0, s20
    global_load_lds_dwordx4 v7, s[10:11]
    global_load_lds_dwordx4 v8, s[10:11] offset:1024
    s_add_u32 m0, s24, 34816
    s_add_u32 s14, s14, 27648
    s_addc_u32 s15, s15, 0
    global_load_lds_dwordx4 v6, s[14:15]
    global_load_lds_dwordx4 v9, s[14:15] offset:1024
    s_add_u32 m0, m0, 16384
    s_add_u32 s10, s10, 18432
    s_addc_u32 s11, s11, 0
    global_load_lds_dwordx4 v7, s[10:11]
    global_load_lds_dwordx4 v8, s[10:11] offset:1024
    s_lshr_b32 s28, s31, 4
    s_lshl_b32 s29, s28, 11
    s_add_u32 s29, s29, 14839808
    s_cmp_lt_u32 s28, 8
    s_cselect_b32 s29, s29, 14835712
    s_cselect_b32 s28, 15, 31
    v_and_b32 v16, s28, v0
    v_lshl_add_u32 v16, v16, 7, s29
    v_lshrrev_b32 v17, 4, v0
    v_and_b32 v18, 3, v0
    v_xor_b32 v17, v17, v18
    v_min_u32 v17, 1, v17
    v_lshrrev_b32 v18, 2, v0
    v_mul_u32_u24 v18, 9216, v18
    v_lshl_add_u32 v17, v17, 4, v18
    s_lshl_b32 s29, s31, 5
    s_add_u32 s29, s29, 10100736
    s_waitcnt vmcnt(8)
    s_barrier
    s_mul_i32 s25, s20, 221184
    s_lshl_b32 s26, s20, 7
    s_add_u32 s14, s12, s25
    s_addc_u32 s15, s13, 0
    s_add_u32 s10, s8, s26
    s_addc_u32 s11, s9, 0
    s_add_u32 m0, s24, 65536
    s_add_u32 s20, s20, 1
    global_load_lds_dwordx4 v6, s[14:15]
    global_load_lds_dwordx4 v9, s[14:15] offset:1024
    s_add_u32 m0, m0, 16384
    s_cmp_eq_u32 s20, 4
    s_cselect_b32 s20, 0, s20
    global_load_lds_dwordx4 v7, s[10:11]
    global_load_lds_dwordx4 v8, s[10:11] offset:1024
    s_add_u32 m0, s24, 67584
    s_add_u32 s14, s14, 27648
    s_addc_u32 s15, s15, 0
    global_load_lds_dwordx4 v6, s[14:15]
    global_load_lds_dwordx4 v9, s[14:15] offset:1024
    s_add_u32 m0, m0, 16384
    s_add_u32 s10, s10, 18432
    s_addc_u32 s11, s11, 0
    global_load_lds_dwordx4 v7, s[10:11]
    global_load_lds_dwordx4 v8, s[10:11] offset:1024
    s_waitcnt vmcnt(8)
    s_barrier
    s_mul_i32 s25, s20, 221184
    s_lshl_b32 s26, s20, 7
    s_add_u32 s14, s12, s25
    s_addc_u32 s15, s13, 0
    s_add_u32 s10, s8, s26
    s_addc_u32 s11, s9, 0
    s_add_u32 m0, s24, 98304
    s_add_u32 s20, s20, 1
    global_load_lds_dwordx4 v6, s[14:15]
    global_load_lds_dwordx4 v9, s[14:15] offset:1024
    s_add_u32 m0, m0, 16384
    s_cmp_eq_u32 s20, 4
    s_cselect_b32 s20, 0, s20
    global_load_lds_dwordx4 v7, s[10:11]
    global_load_lds_dwordx4 v8, s[10:11] offset:1024
    s_add_u32 m0, s24, 100352
    s_add_u32 s14, s14, 27648
    s_addc_u32 s15, s15, 0
    global_load_lds_dwordx4 v6, s[14:15]
    global_load_lds_dwordx4 v9, s[14:15] offset:1024
    s_add_u32 m0, m0, 16384
    s_add_u32 s10, s10, 18432
    s_addc_u32 s11, s11, 0
    global_load_lds_dwordx4 v7, s[10:11]
    global_load_lds_dwordx4 v8, s[10:11] offset:1024
    s_waitcnt vmcnt(8)
    s_barrier
    s_mul_i32 s25, s21, 221184
    s_lshl_b32 s26, s21, 7
    s_add_u32 s14, s12, s25
    s_addc_u32 s15, s13, 0
    s_add_u32 s10, s8, s26
    s_addc_u32 s11, s9, 0
    s_add_u32 m0, s24, 0
    s_add_u32 s21, s21, 1
    global_load_lds_dwordx4 v6, s[14:15]
    global_load_lds_dwordx4 v9, s[14:15] offset:1024
    s_add_u32 m0, m0, 16384
    s_cmp_eq_u32 s21, 9
    s_cselect_b32 s21, 4, s21
    global_load_lds_dwordx4 v7, s[10:11]
    global_load_lds_dwordx4 v8, s[10:11] offset:1024
    s_add_u32 m0, s24, 2048
    s_add_u32 s14, s14, 27648
    s_addc_u32 s15, s15, 0
    global_load_lds_dwordx4 v6, s[14:15]
    global_load_lds_dwordx4 v9, s[14:15] offset:1024
    s_add_u32 m0, m0, 16384
    s_add_u32 s10, s10, 18432
    s_addc_u32 s11, s11, 0
    global_load_lds_dwordx4 v7, s[10:11]
    global_load_lds_dwordx4 v8, s[10:11] offset:1024
    s_waitcnt vmcnt(8)
    s_barrier
    s_mul_i32 s25, s21, 221184
    s_lshl_b32 s26, s21, 7
    s_add_u32 s14, s12, s25
    s_addc_u32 s15, s13, 0
    s_add_u32 s10, s8, s26
    s_addc_u32 s11, s9, 0
    s_add_u32 m0, s24, 32768
    s_add_u32 s21, s21, 1
    global_load_lds_dwordx4 v6, s[14:15]
    global_load_lds_dwordx4 v9, s[14:15] offset:1024
    s_add_u32 m0, m0, 16384
    s_cmp_eq_u32 s21, 9
    s_cselect_b32 s21, 4, s21
    global_load_lds_dwordx4 v7, s[10:11]
    global_load_lds_dwordx4 v8, s[10:11] offset:1024
    s_add_u32 m0, s24, 34816
    s_add_u32 s14, s14, 27648
    s_addc_u32 s15, s15, 0
    global_load_lds_dwordx4 v6, s[14:15]
    global_load_lds_dwordx4 v9, s[14:15] offset:1024
    s_add_u32 m0, m0, 16384
    s_add_u32 s10, s10, 18432
    s_addc_u32 s11, s11, 0
    global_load_lds_dwordx4 v7, s[10:11]
    global_load_lds_dwordx4 v8, s[10:11] offset:1024
    s_load_dword s74, s[56:57], 0
    s_waitcnt vmcnt(8)
    s_barrier
    s_mul_i32 s25, s21, 221184
    s_lshl_b32 s26, s21, 7
    s_add_u32 s14, s12, s25
    s_addc_u32 s15, s13, 0
    s_add_u32 s10, s8, s26
    s_addc_u32 s11, s9, 0
    s_add_u32 m0, s24, 65536
    s_add_u32 s21, s21, 1
    global_load_lds_dwordx4 v6, s[14:15]
    global_load_lds_dwordx4 v9, s[14:15] offset:1024
    s_add_u32 m0, m0, 16384
    s_cmp_eq_u32 s21, 9
    s_cselect_b32 s21, 4, s21
    global_load_lds_dwordx4 v7, s[10:11]
    global_load_lds_dwordx4 v8, s[10:11] offset:1024
    s_add_u32 m0, s24, 67584
    s_add_u32 s14, s14, 27648
    s_addc_u32 s15, s15, 0
    global_load_lds_dwordx4 v6, s[14:15]
    global_load_lds_dwordx4 v9, s[14:15] offset:1024
    s_add_u32 m0, m0, 16384
    s_add_u32 s10, s10, 18432
    s_addc_u32 s11, s11, 0
    global_load_lds_dwordx4 v7, s[10:11]
    global_load_lds_dwordx4 v8, s[10:11] offset:1024
    s_waitcnt vmcnt(8)
    s_barrier
    s_mul_i32 s25, s21, 221184
    s_lshl_b32 s26, s21, 7
    s_add_u32 s14, s12, s25
    s_addc_u32 s15, s13, 0
    s_add_u32 s10, s8, s26
    s_addc_u32 s11, s9, 0
    s_add_u32 m0, s24, 98304
    s_add_u32 s21, s21, 1
    global_load_lds_dwordx4 v6, s[14:15]
    global_load_lds_dwordx4 v9, s[14:15] offset:1024
    s_add_u32 m0, m0, 16384
    s_cmp_eq_u32 s21, 9
    s_cselect_b32 s21, 4, s21
    global_load_lds_dwordx4 v7, s[10:11]
    global_load_lds_dwordx4 v8, s[10:11] offset:1024
    s_add_u32 m0, s24, 100352
    s_add_u32 s14, s14, 27648
    s_addc_u32 s15, s15, 0
    global_load_lds_dwordx4 v6, s[14:15]
    global_load_lds_dwordx4 v9, s[14:15] offset:1024
    s_add_u32 m0, m0, 16384
    s_add_u32 s10, s10, 18432
    s_addc_u32 s11, s11, 0
    global_load_lds_dwordx4 v7, s[10:11]
    global_load_lds_dwordx4 v8, s[10:11] offset:1024
    s_waitcnt vmcnt(8)
    s_barrier
    s_mul_i32 s25, s21, 221184
    s_lshl_b32 s26, s21, 7
    s_add_u32 s14, s12, s25
    s_addc_u32 s15, s13, 0
    s_add_u32 s10, s8, s26
    s_addc_u32 s11, s9, 0
    s_add_u32 m0, s24, 0
    s_add_u32 s21, s21, 1
    global_load_lds_dwordx4 v6, s[14:15]
    global_load_lds_dwordx4 v9, s[14:15] offset:1024
    s_add_u32 m0, m0, 16384
    s_cmp_eq_u32 s21, 9
    s_cselect_b32 s21, 4, s21
    global_load_lds_dwordx4 v7, s[10:11]
    global_load_lds_dwordx4 v8, s[10:11] offset:1024
    s_add_u32 m0, s24, 2048
    s_add_u32 s14, s14, 27648
    s_addc_u32 s15, s15, 0
    global_load_lds_dwordx4 v6, s[14:15]
    global_load_lds_dwordx4 v9, s[14:15] offset:1024
    s_add_u32 m0, m0, 16384
    s_add_u32 s10, s10, 18432
    s_addc_u32 s11, s11, 0
    global_load_lds_dwordx4 v7, s[10:11]
    global_load_lds_dwordx4 v8, s[10:11] offset:1024
    s_waitcnt vmcnt(8) lgkmcnt(0)
    s_barrier
    s_cmp_eq_u32 s3, 3
    s_cbranch_scc1 L_W3
    s_cmp_eq_u32 s3, 2
    s_cbranch_scc1 F_GATE
    s_waitcnt vmcnt(0)
    s_barrier
    s_branch F_ATTN
L_W3:
    buffer_load_dword v12, v16, s[16:19], 0 offen sc1
    s_waitcnt vmcnt(1)
    s_barrier
    s_waitcnt lgkmcnt(0)
    s_cmp_lg_u32 s74, 0
    s_cbranch_scc1 L_NOK
    s_sleep 8
    s_load_dword s74, s[56:57], 64
    s_waitcnt lgkmcnt(0)
    s_cmp_lg_u32 s74, 0
    s_cbranch_scc1 L_NOK
    s_sleep 8
    s_load_dword s74, s[56:57], 128
    s_waitcnt lgkmcnt(0)
    s_cmp_lg_u32 s74, 0
    s_cbranch_scc1 L_NOK
    s_sleep 8
    s_load_dword s74, s[56:57], 192
    s_waitcnt lgkmcnt(0)
    s_cmp_lg_u32 s74, 0
    s_cbranch_scc1 L_NOK
    s_sleep 8
    s_mov_b32 s97, 262144
    v_mov_b32 v20, 0
L_NL:
    global_load_dword v21, v20, s[56:57] sc1
    s_waitcnt vmcnt(0)
    v_readfirstlane_b32 s74, v21
    s_cmp_lg_u32 s74, 0
    s_cbranch_scc1 L_NOK
    s_sub_u32 s97, s97, 1
    s_cbranch_scc0 L_NL
    s_mov_b32 s74, 1
L_NOK:
    v_mov_b32 v21, s74
    ds_write_b32 v3, v21 offset:96
    s_waitcnt vmcnt(0)
    v_cmp_ne_u32 vcc, s74, v12
    s_cmp_eq_u64 vcc, 0
    s_cbranch_scc1 L_GI
    s_mov_b32 s97, 262144
FW_1:
    buffer_load_dword v12, v16, s[16:19], 0 offen sc1
    s_waitcnt vmcnt(0)
    v_xor_b32 v12, s74, v12
    v_cmp_ne_u32 vcc, 0, v12
    s_cmp_eq_u64 vcc, 0
    s_cbranch_scc1 FWOK_2
    s_sleep 2
    s_sub_u32 s97, s97, 1
    s_cbranch_scc0 FW_1
FWOK_2:
L_GI:
    v_mov_b32 v18, 0x7ff00000
    s_mov_b32 m0, 32768
    s_nop 0
    buffer_load_dwordx4 v18, s[16:19], 0 offen lds
    buffer_load_dwordx4 v18, s[16:19], 0 offen offset:1024 lds
    s_mov_b32 m0, 34816
    s_add_u32 s27, s29, 0
    buffer_load_dwordx4 v17, s[16:19], s27 offen sc1 lds
    s_mov_b32 m0, 35840
    s_add_u32 s27, s29, 147456
    buffer_load_dwordx4 v17, s[16:19], s27 offen sc1 lds
    s_mov_b32 m0, 36864
    s_add_u32 s27, s29, 294912
    buffer_load_dwordx4 v17, s[16:19], s27 offen sc1 lds
    s_mov_b32 m0, 37888
    s_add_u32 s27, s29, 442368
    buffer_load_dwordx4 v17, s[16:19], s27 offen sc1 lds
    s_mov_b32 m0, 38912
    s_add_u32 s27, s29, 589824
    buffer_load_dwordx4 v17, s[16:19], s27 offen sc1 lds
    s_mov_b32 m0, 39936
    s_add_u32 s27, s29, 737280
    buffer_load_dwordx4 v17, s[16:19], s27 offen sc1 lds
    s_mov_b32 m0, 40960
    s_add_u32 s27, s29, 884736
    buffer_load_dwordx4 v17, s[16:19], s27 offen sc1 lds
    s_mov_b32 m0, 41984
    s_add_u32 s27, s29, 1032192
    buffer_load_dwordx4 v17, s[16:19], s27 offen sc1 lds
    s_mov_b32 m0, 43008
    s_add_u32 s27, s29, 1179648
    buffer_load_dwordx4 v17, s[16:19], s27 offen sc1 lds
    s_mov_b32 m0, 44032
    s_add_u32 s27, s29, 1327104
    buffer_load_dwordx4 v17, s[16:19], s27 offen sc1 lds
    s_mov_b32 m0, 45056
    s_add_u32 s27, s29, 1474560
    buffer_load_dwordx4 v17, s[16:19], s27 offen sc1 lds
    s_mov_b32 m0, 46080
    s_add_u32 s27, s29, 1622016
    buffer_load_dwordx4 v17, s[16:19], s27 offen sc1 lds
    s_mov_b32 m0, 47104
    s_add_u32 s27, s29, 1769472
    buffer_load_dwordx4 v17, s[16:19], s27 offen sc1 lds
    s_mov_b32 m0, 48128
    s_add_u32 s27, s29, 1916928
    buffer_load_dwordx4 v17, s[16:19], s27 offen sc1 lds
    s_mov_b32 m0, 49152
    s_add_u32 s27, s29, 2064384
    buffer_load_dwordx4 v17, s[16:19], s27 offen sc1 lds
    s_mov_b32 m0, 50176
    s_add_u32 s27, s29, 2211840
    buffer_load_dwordx4 v17, s[16:19], s27 offen sc1 lds
L_GD:
    s_waitcnt vmcnt(0)
    s_mov_b64 exec, 1
    ds_add_u32 v3, v1 offset:0
    s_mov_b64 exec, -1
    s_branch F_ATTN
F_NONCE:
    s_memrealtime s[60:61]
    v_lshlrev_b32 v15, 6, v0
    s_waitcnt lgkmcnt(0)
    s_or_b32 s60, s60, 1
    v_mov_b32 v14, s60
    s_mov_b64 exec, 15
    global_store_dword v15, v14, s[56:57] sc1
    s_mov_b64 exec, -1
    s_branch F_NN
F_OTHER:
    s_cmp_ge_u32 s2, 224
    s_cselect_b32 s27, 4, 8
    s_cmp_lt_u32 s3, s27
    s_cbranch_scc1 F_MAIN
    s_bfe_u32 s8, s3, 0x20001
    s_and_b32 s9, s3, 1
    s_cmp_ge_u32 s2, 224
    s_cselect_b32 s30, 2, 1
    s_mov_b32 s29, 131072
    s_cselect_b32 s29, 113408, s29
    s_lshl_b32 s4, s31, 1
    s_add_u32 s4, s4, s8
    s_lshl_b32 s6, s4, 8
    s_lshl_b32 s7, s9, 7
    s_add_u32 s6, s6, s7
    v_lshl_add_u32 v14, v0, 1, s6
    s_lshl_b32 s6, s4, 1
    v_mov_b32 v15, s6
    s_cmp_lg_u32 s30, 1
    s_cbranch_scc0 K_NF
    s_setprio 1
    global_load_ushort v8, v15, s[42:43] offset:0
    global_load_ushort v9, v14, s[34:35] offset:0
    global_load_ushort v10, v14, s[36:37] offset:0
    global_load_ushort v11, v14, s[38:39] offset:0
    global_load_ushort v12, v14, s[40:41] offset:0
    global_load_ushort v157, v15, s[44:45] offset:0
    s_barrier
    s_branch K_NF
F_MAIN:
    s_cmp_lt_u32 s2, 224
    s_cbranch_scc1 F_GEMM
    s_setprio 3
    s_sub_u32 s21, s2, 224
    s_and_b32 s4, s2, 3
    s_lshl_b32 s4, s4, 3
    s_lshr_b32 s5, s21, 2
    s_add_u32 s4, s4, s5
    s_lshl_b32 s4, s4, 2
    s_add_u32 s4, s4, s3
    s_mov_b32 s10, 2359296
    s_mov_b32 s11, 0x20000
    s_mul_i32 s5, s4, 18432
    s_mul_i32 s20, s3, 10240
    v_lshlrev_b32 v6, 4, v0
    v_add_u32 v7, 0, v0
    v_mul_u32_u24 v8, 205, v7
    v_lshrrev_b32 v8, 13, v8
    v_lshlrev_b32 v8, 9, v8
    v_lshl_add_u32 v24, v7, 4, v8
    v_add_u32 v7, 64, v0
    v_mul_u32_u24 v8, 205, v7
    v_lshrrev_b32 v8, 13, v8
    v_lshlrev_b32 v8, 9, v8
    v_lshl_add_u32 v25, v7, 4, v8
    v_add_u32 v7, 128, v0
    v_mul_u32_u24 v8, 205, v7
    v_lshrrev_b32 v8, 13, v8
    v_lshlrev_b32 v8, 9, v8
    v_lshl_add_u32 v26, v7, 4, v8
    v_add_u32 v7, 192, v0
    v_mul_u32_u24 v8, 205, v7
    v_lshrrev_b32 v8, 13, v8
    v_lshlrev_b32 v8, 9, v8
    v_lshl_add_u32 v27, v7, 4, v8
    v_add_u32 v7, 256, v0
    v_mul_u32_u24 v8, 205, v7
    v_lshrrev_b32 v8, 13, v8
    v_lshlrev_b32 v8, 9, v8
    v_lshl_add_u32 v28, v7, 4, v8
    s_add_u32 s6, s5, 512
    s_add_u32 m0, s20, 0
    s_nop 0
    buffer_load_dwordx4 v24, s[8:11], s6 offen lds
    s_add_u32 m0, s20, 1024
    s_nop 0
    buffer_load_dwordx4 v25, s[8:11], s6 offen lds
    s_add_u32 m0, s20, 2048
    s_nop 0
    buffer_load_dwordx4 v26, s[8:11], s6 offen lds
    s_add_u32 m0, s20, 3072
    s_nop 0
    buffer_load_dwordx4 v27, s[8:11], s6 offen lds
    s_add_u32 m0, s20, 4096
    s_nop 0
    buffer_load_dwordx4 v28, s[8:11], s6 offen lds
    s_add_u32 s6, s5, 9728
    s_add_u32 m0, s20, 5120
    s_nop 0
    buffer_load_dwordx4 v24, s[8:11], s6 offen lds
    s_add_u32 m0, s20, 6144
    s_nop 0
    buffer_load_dwordx4 v25, s[8:11], s6 offen lds
    s_add_u32 m0, s20, 7168
    s_nop 0
    buffer_load_dwordx4 v26, s[8:11], s6 offen lds
    s_add_u32 m0, s20, 8192
    s_nop 0
    buffer_load_dwordx4 v27, s[8:11], s6 offen lds
    s_add_u32 m0, s20, 9216
    s_nop 0
    buffer_load_dwordx4 v28, s[8:11], s6 offen lds
    s_barrier
    v_bfe_u32 v9, v0, 2, 2
    v_mul_u32_u24 v9, 640, v9
    v_lshrrev_b32 v10, 4, v0
    v_lshl_add_u32 v9, v10, 5, v9
    v_and_b32 v10, 3, v0
    v_lshl_add_u32 v9, v10, 3, v9
    v_add_u32 v9, s20, v9
    s_waitcnt vmcnt(0)
    ds_read_b64_tr_b16 v[32:33], v9 offset:0
    ds_read_b64_tr_b16 v[34:35], v9 offset:2560
    ds_read_b64_tr_b16 v[36:37], v9 offset:128
    ds_read_b64_tr_b16 v[38:39], v9 offset:2688
    ds_read_b64_tr_b16 v[40:41], v9 offset:256
    ds_read_b64_tr_b16 v[42:43], v9 offset:2816
    ds_read_b64_tr_b16 v[44:45], v9 offset:384
    ds_read_b64_tr_b16 v[46:47], v9 offset:2944
    ds_read_b64_tr_b16 v[48:49], v9 offset:512
    ds_read_b64_tr_b16 v[50:51], v9 offset:3072
    s_add_u32 s6, s5, 10104832
    s_waitcnt lgkmcnt(0)
    buffer_store_dwordx4 v[32:35], v6, s[16:19], s6 offen offset:0 sc1
    buffer_store_dwordx4 v[36:39], v6, s[16:19], s6 offen offset:1024 sc1
    buffer_store_dwordx4 v[40:43], v6, s[16:19], s6 offen offset:2048 sc1
    buffer_store_dwordx4 v[44:47], v6, s[16:19], s6 offen offset:3072 sc1
    s_add_u32 s6, s6, 4096
    buffer_store_dwordx4 v[48:51], v6, s[16:19], s6 offen offset:0 sc1
    ds_read_b64_tr_b16 v[52:53], v9 offset:5120
    ds_read_b64_tr_b16 v[54:55], v9 offset:7680
    ds_read_b64_tr_b16 v[56:57], v9 offset:5248
    ds_read_b64_tr_b16 v[58:59], v9 offset:7808
    ds_read_b64_tr_b16 v[60:61], v9 offset:5376
    ds_read_b64_tr_b16 v[62:63], v9 offset:7936
    ds_read_b64_tr_b16 v[64:65], v9 offset:5504
    ds_read_b64_tr_b16 v[66:67], v9 offset:8064
    ds_read_b64_tr_b16 v[68:69], v9 offset:5632
    ds_read_b64_tr_b16 v[70:71], v9 offset:8192
    s_add_u32 s6, s5, 10114048
    s_waitcnt lgkmcnt(0)
    buffer_store_dwordx4 v[52:55], v6, s[16:19], s6 offen offset:0 sc1
    buffer_store_dwordx4 v[56:59], v6, s[16:19], s6 offen offset:1024 sc1
    buffer_store_dwordx4 v[60:63], v6, s[16:19], s6 offen offset:2048 sc1
    buffer_store_dwordx4 v[64:67], v6, s[16:19], s6 offen offset:3072 sc1
    s_add_u32 s6, s6, 4096
    buffer_store_dwordx4 v[68:71], v6, s[16:19], s6 offen offset:0 sc1
    s_load_dword s74, s[56:57], 0
    s_waitcnt lgkmcnt(0)
    s_cmp_lg_u32 s74, 0
    s_cbranch_scc1 R_NOK
    s_sleep 8
    s_load_dword s74, s[56:57], 64
    s_waitcnt lgkmcnt(0)
    s_cmp_lg_u32 s74, 0
    s_cbranch_scc1 R_NOK
    s_sleep 8
    s_load_dword s74, s[56:57], 128
    s_waitcnt lgkmcnt(0)
    s_cmp_lg_u32 s74, 0
    s_cbranch_scc1 R_NOK
    s_sleep 8
    s_load_dword s74, s[56:57], 192
    s_waitcnt lgkmcnt(0)
    s_cmp_lg_u32 s74, 0
    s_cbranch_scc1 R_NOK
    s_sleep 8
    s_mov_b32 s97, 262144
    v_mov_b32 v20, 0
R_NL:
    global_load_dword v21, v20, s[56:57] sc1
    s_waitcnt vmcnt(0)
    v_readfirstlane_b32 s74, v21
    s_cmp_lg_u32 s74, 0
    s_cbranch_scc1 R_NOK
    s_sub_u32 s97, s97, 1
    s_cbranch_scc0 R_NL
    s_mov_b32 s74, 1
R_NOK:
    v_mov_b32 v21, s74
    ds_write_b32 v3, v21 offset:96
    s_lshl_b32 s7, s21, 7
    s_add_u32 s7, s7, 14835712
    s_waitcnt vmcnt(0)
    s_mov_b64 exec, 1
    ds_add_rtn_u32 v2, v3, v1 offset:32
    s_mov_b64 exec, -1
    s_waitcnt lgkmcnt(0)
    v_readfirstlane_b32 s96, v2
    s_cmp_lg_u32 s96, 3
    s_cbranch_scc1 PB_3
    v_mov_b32 v12, 0
    v_mov_b32 v13, s74
    s_mov_b64 exec, 1
    buffer_store_dword v13, v12, s[16:19], s7 offen sc1
    s_mov_b64 exec, -1
PB_3:
    s_mov_b64 exec, 1
    ds_add_u32 v3, v1 offset:4
    s_mov_b64 exec, -1
    s_setprio 0
    s_cmp_eq_u32 s3, 2
    s_cbranch_scc1 F_GATE
    s_cmp_lg_u32 s3, 3
    s_cbranch_scc1 F_ATTN
    s_setprio 3
    s_lshr_b32 s28, s31, 4
    s_lshl_b32 s29, s28, 11
    s_add_u32 s29, s29, 14839808
    s_cmp_lt_u32 s28, 8
    s_cselect_b32 s29, s29, 14835712
    s_cselect_b32 s28, 15, 31
    v_and_b32 v16, s28, v0
    v_lshl_add_u32 v16, v16, 7, s29
    v_lshrrev_b32 v17, 4, v0
    v_and_b32 v18, 3, v0
    v_xor_b32 v17, v17, v18
    v_min_u32 v17, 3, v17
    v_lshrrev_b32 v18, 2, v0
    v_mul_u32_u24 v18, 9216, v18
    v_lshl_add_u32 v17, v17, 4, v18
    s_lshl_b32 s29, s31, 5
    s_add_u32 s29, s29, 10100736
    s_mov_b32 s97, 4194304
LW_4:
    ds_read_b32 v2, v3 offset:32
    s_waitcnt lgkmcnt(0)
    v_readfirstlane_b32 s96, v2
    s_cmp_ge_u32 s96, 4
    s_cbranch_scc1 LWOK_5
    s_sleep 2
    s_sub_u32 s97, s97, 1
    s_cbranch_scc0 LW_4
LWOK_5:
    s_mov_b32 s97, 262144
FW_6:
    buffer_load_dword v12, v16, s[16:19], 0 offen sc1
    s_waitcnt vmcnt(0)
    v_xor_b32 v12, s74, v12
    v_cmp_ne_u32 vcc, 0, v12
    s_cmp_eq_u64 vcc, 0
    s_cbranch_scc1 FWOK_7
    s_sleep 2
    s_sub_u32 s97, s97, 1
    s_cbranch_scc0 FW_6
FWOK_7:
    v_mov_b32 v18, 0x7ff00000
    s_mov_b32 m0, 32768
    s_nop 0
    buffer_load_dwordx4 v18, s[16:19], 0 offen lds
    buffer_load_dwordx4 v18, s[16:19], 0 offen offset:1024 lds
    s_mov_b32 m0, 34816
    s_add_u32 s27, s29, 0
    buffer_load_dwordx4 v17, s[16:19], s27 offen sc1 lds
    s_mov_b32 m0, 35840
    s_add_u32 s27, s29, 147456
    buffer_load_dwordx4 v17, s[16:19], s27 offen sc1 lds
    s_mov_b32 m0, 36864
    s_add_u32 s27, s29, 294912
    buffer_load_dwordx4 v17, s[16:19], s27 offen sc1 lds
    s_mov_b32 m0, 37888
    s_add_u32 s27, s29, 442368
    buffer_load_dwordx4 v17, s[16:19], s27 offen sc1 lds
    s_mov_b32 m0, 38912
    s_add_u32 s27, s29, 589824
    buffer_load_dwordx4 v17, s[16:19], s27 offen sc1 lds
    s_mov_b32 m0, 39936
    s_add_u32 s27, s29, 737280
    buffer_load_dwordx4 v17, s[16:19], s27 offen sc1 lds
    s_mov_b32 m0, 40960
    s_add_u32 s27, s29, 884736
    buffer_load_dwordx4 v17, s[16:19], s27 offen sc1 lds
    s_mov_b32 m0, 41984
    s_add_u32 s27, s29, 1032192
    buffer_load_dwordx4 v17, s[16:19], s27 offen sc1 lds
    s_mov_b32 m0, 43008
    s_add_u32 s27, s29, 1179648
    buffer_load_dwordx4 v17, s[16:19], s27 offen sc1 lds
    s_mov_b32 m0, 44032
    s_add_u32 s27, s29, 1327104
    buffer_load_dwordx4 v17, s[16:19], s27 offen sc1 lds
    s_mov_b32 m0, 45056
    s_add_u32 s27, s29, 1474560
    buffer_load_dwordx4 v17, s[16:19], s27 offen sc1 lds
    s_mov_b32 m0, 46080
    s_add_u32 s27, s29, 1622016
    buffer_load_dwordx4 v17, s[16:19], s27 offen sc1 lds
    s_mov_b32 m0, 47104
    s_add_u32 s27, s29, 1769472
    buffer_load_dwordx4 v17, s[16:19], s27 offen sc1 lds
    s_mov_b32 m0, 48128
    s_add_u32 s27, s29, 1916928
    buffer_load_dwordx4 v17, s[16:19], s27 offen sc1 lds
    s_mov_b32 m0, 49152
    s_add_u32 s27, s29, 2064384
    buffer_load_dwordx4 v17, s[16:19], s27 offen sc1 lds
    s_mov_b32 m0, 50176
    s_add_u32 s27, s29, 2211840
    buffer_load_dwordx4 v17, s[16:19], s27 offen sc1 lds
    s_waitcnt vmcnt(0)
    s_mov_b64 exec, 1
    ds_add_u32 v3, v1 offset:0
    s_mov_b64 exec, -1
    s_setprio 0
    s_sleep 8
    s_mov_b64 exec, 1
    ds_add_u32 v3, v1 offset:116
    s_mov_b64 exec, -1
    s_branch F_ATTN
F_GEMM:
    s_sub_u32 s8, s3, 4
    s_lshl_b32 s6, s4, 2
    s_add_u32 s6, s6, s8
    v_bfe_u32 v10, v0, 2, 2
    v_bfe_u32 v11, v0, 4, 1
    v_and_b32 v12, 3, v0
    v_lshlrev_b32 v6, 11, v5
    v_lshl_add_u32 v6, v10, 8, v6
    v_lshl_add_u32 v6, v11, 5, v6
    v_lshl_add_u32 v6, v12, 3, v6
    v_add_u32 v12, 0, v10
    v_and_b32 v12, 3, v12
    v_lshl_add_u32 v148, v12, 6, v6
    v_add_u32 v152, 0x10000, v148
    v_add_u32 v12, 1, v10
    v_and_b32 v12, 3, v12
    v_lshl_add_u32 v149, v12, 6, v6
    v_add_u32 v153, 0x10000, v149
    v_add_u32 v12, 2, v10
    v_and_b32 v12, 3, v12
    v_lshl_add_u32 v150, v12, 6, v6
    v_add_u32 v154, 0x10000, v150
    v_add_u32 v12, 3, v10
    v_and_b32 v12, 3, v12
    v_lshl_add_u32 v151, v12, 6, v6
    v_add_u32 v155, 0x10000, v151
    s_lshl_b32 s7, s8, 12
    s_add_u32 s7, s7, 16384
    v_lshl_add_u32 v14, v4, 7, s7
    v_bfe_u32 v15, v4, 1, 3
    v_xor_b32 v15, v15, v5
    v_xor_b32 v12, 0, v15
    v_lshl_add_u32 v140, v12, 4, v14
    v_add_u32 v144, 0x10000, v140
    v_xor_b32 v12, 2, v15
    v_lshl_add_u32 v141, v12, 4, v14
    v_add_u32 v145, 0x10000, v141
    v_xor_b32 v12, 4, v15
    v_lshl_add_u32 v142, v12, 4, v14
    v_add_u32 v146, 0x10000, v142
    v_xor_b32 v12, 6, v15
    v_lshl_add_u32 v143, v12, 4, v14
    v_add_u32 v147, 0x10000, v143
    v_lshrrev_b32 v14, 1, v4
    v_xor_b32 v14, v14, v4
    v_and_b32 v14, 4, v14
    v_mul_u32_u24 v14, 3, v14
    v_xor_b32 v13, v4, v14
    v_lshlrev_b32 v156, 4, v13
    v_lshl_add_u32 v156, v5, 3, v156
    v_mul_u32_u24 v157, 9216, v5
    v_lshl_add_u32 v157, v4, 4, v157
    s_mul_i32 s26, s6, 110592
    s_lshl_b32 s27, s5, 13
    s_add_u32 s20, s26, s27
    s_add_u32 s21, s20, 4096
    s_lshl_b32 s27, s5, 11
    s_add_u32 s22, s26, s27
    s_add_u32 s22, s22, 55296
    s_add_u32 s23, s22, 18432
    s_mov_b32 s28, 0x3eae1a93
    s_mov_b32 s29, s28
    s_lshl_b32 s24, s5, 4
    s_add_u32 s24, s24, s4
    s_lshl_b32 s24, s24, 7
    s_add_u32 s24, s24, 14856192
    s_mov_b32 s34, s20
    s_mov_b32 s35, s21
    s_mov_b32 s36, s22
    s_mov_b32 s37, s23
    s_mov_b32 s38, s24
    s_mov_b64 s[40:41], s[28:29]
    s_mov_b32 s42, s5
    s_and_b32 s4, s2, 7
    s_lshl_b32 s4, s4, 2
    s_bfe_u32 s5, s2, 0x20003
    s_add_u32 s4, s4, s5
    s_lshr_b32 s5, s2, 5
    s_lshr_b32 s6, s3, 2
    s_and_b32 s7, s3, 3
    s_lshl_b32 s7, s7, 1
    s_lshl_b32 s5, s5, 3
    s_add_u32 s7, s5, s7
    s_mov_b32 s30, s7
    s_add_u32 s31, s30, 1
    s_mul_i32 s12, s4, 18
    s_lshr_b32 s13, s12, 3
    s_lshl_b32 s8, s13, 9
    s_add_u32 s9, s8, 36864
    v_lshl_add_u32 v7, v0, 4, s9
    v_lshlrev_b32 v8, 4, v4
    v_lshl_add_u32 v8, v5, 3, v8
    s_add_u32 s9, s9, 1024
    v_add_u32 v8, s9, v8
    v_subrev_u32 v163, 36864, v7
    v_subrev_u32 v164, 36864, v8
    s_mul_i32 s24, s30, 110592
    s_mul_i32 s25, s31, 110592
    v_mul_u32_u24 v9, 9216, v5
    v_lshl_add_u32 v9, v4, 4, v9
    s_lshl_b32 s9, s12, 4
    s_add_u32 s9, s9, 73728
    v_add_u32 v9, s9, v9
    v_add_u32 v162, 18432, v9
    s_mov_b32 s22, 0x3ffff
    s_mov_b32 s23, 0x3ffff
    s_mul_i32 s14, s6, 3538944
    s_add_u32 s29, s14, 3538944
    s_mov_b32 s28, s14
    v_mov_b32 v6, 0xdddddddd
    s_mov_b32 s15, 0
    v_mov_b32 v10, 1065369472
    v_and_b32 v11, 27, v4
    v_cmp_eq_u32 vcc, 18, v11
    s_and_b32 s9, s4, 3
    v_lshlrev_b32 v12, 2, v5
    v_cndmask_b32 v10, 0, v10, vcc
    v_subrev_u32 v12, s9, v12
    v_cmp_le_i32 s[60:61], 0, v12
    v_cmp_le_i32 s[62:63], -1, v12
    v_cmp_le_i32 s[64:65], -2, v12
    v_cmp_le_i32 s[66:67], -3, v12
    v_lshlrev_b32 v12, 1, v5
    v_subrev_u32 v12, s9, v12
    v_cmp_ge_i32 s[68:69], 0, v12
    v_cmp_ge_i32 s[70:71], -1, v12
    v_bfe_u32 v11, v0, 3, 2
    v_and_b32 v12, 1, v11
    s_add_u32 s9, s13, 72
    v_lshl_add_u32 v13, v12, 1, s9
    v_lshrrev_b32 v13, 4, v13
    s_add_u32 s9, s12, 1152
    v_mad_u32_u24 v14, v12, 17, s9
    v_lshrrev_b32 v14, 7, v14
    v_cmp_gt_u32 vcc, 2, v11
    v_lshl_add_u32 v15, v12, 1, s13
    v_lshrrev_b32 v15, 4, v15
    v_cndmask_b32 v13, v14, v13, vcc
    v_and_b32 v11, 7, v0
    s_lshl_b32 s9, s6, 3
    v_add_u32 v14, s9, v11
    v_lshl_add_u32 v13, v13, 4, v14
    v_and_b32 v11, 1, v0
    s_lshr_b32 s9, s5, 2
    v_add_u32 v11, s9, v11
    v_cmp_eq_u32 vcc, 0, v5
    v_lshl_add_u32 v15, v15, 4, v11
    s_lshl_b32 s26, s6, 2
    v_cndmask_b32 v11, v15, v13, vcc
    v_lshlrev_b32 v11, 7, v11
    v_add_u32 v160, 14856192, v11
    v_add_u32 v13, s26, v3
    s_barrier
    ds_read_b128 v[96:99], v140 offset:0
    ds_read_b64_tr_b16 v[80:81], v148 offset:0
    ds_read_b64_tr_b16 v[82:83], v148 offset:1024
    ds_read_b64_tr_b16 v[84:85], v149 offset:0
    ds_read_b64_tr_b16 v[86:87], v149 offset:1024
    ds_read_b64_tr_b16 v[88:89], v150 offset:0
    ds_read_b64_tr_b16 v[90:91], v150 offset:1024
    ds_read_b64_tr_b16 v[92:93], v151 offset:0
    ds_read_b64_tr_b16 v[94:95], v151 offset:1024
    ds_read_b128 v[116:119], v141 offset:0
    ds_read_b64_tr_b16 v[100:101], v148 offset:4096
    ds_read_b64_tr_b16 v[102:103], v148 offset:5120
    ds_read_b64_tr_b16 v[104:105], v149 offset:4096
    ds_read_b64_tr_b16 v[106:107], v149 offset:5120
    ds_read_b64_tr_b16 v[108:109], v150 offset:4096
    ds_read_b64_tr_b16 v[110:111], v150 offset:5120
    ds_read_b64_tr_b16 v[112:113], v151 offset:4096
    ds_read_b64_tr_b16 v[114:115], v151 offset:5120
    s_cmp_ge_u32 s42, 9
    s_cbranch_scc1 G_V
    s_waitcnt lgkmcnt(9)
    v_mfma_f32_32x32x16_bf16 v[16:31], v[80:83], v[96:99], 0
    ds_read_b128 v[136:139], v142 offset:0
    ds_read_b64_tr_b16 v[120:121], v148 offset:8192
    ds_read_b64_tr_b16 v[122:123], v148 offset:9216
    v_mfma_f32_32x32x16_bf16 v[32:47], v[84:87], v[96:99], 0
    ds_read_b64_tr_b16 v[124:125], v149 offset:8192
    ds_read_b64_tr_b16 v[126:127], v149 offset:9216
    v_mfma_f32_32x32x16_bf16 v[48:63], v[88:91], v[96:99], 0
    ds_read_b64_tr_b16 v[128:129], v150 offset:8192
    ds_read_b64_tr_b16 v[130:131], v150 offset:9216
    v_mfma_f32_32x32x16_bf16 v[64:79], v[92:95], v[96:99], 0
    ds_read_b64_tr_b16 v[132:133], v151 offset:8192
    ds_read_b64_tr_b16 v[134:135], v151 offset:9216
    s_waitcnt lgkmcnt(9)
    v_mfma_f32_32x32x16_bf16 v[16:31], v[100:103], v[116:119], v[16:31]
    ds_read_b128 v[96:99], v143 offset:0
    ds_read_b64_tr_b16 v[80:81], v148 offset:12288
    ds_read_b64_tr_b16 v[82:83], v148 offset:13312
    v_mfma_f32_32x32x16_bf16 v[32:47], v[104:107], v[116:119], v[32:47]
    ds_read_b64_tr_b16 v[84:85], v149 offset:12288
    ds_read_b64_tr_b16 v[86:87], v149 offset:13312
    v_mfma_f32_32x32x16_bf16 v[48:63], v[108:111], v[116:119], v[48:63]
    ds_read_b64_tr_b16 v[88:89], v150 offset:12288
    ds_read_b64_tr_b16 v[90:91], v150 offset:13312
    v_mfma_f32_32x32x16_bf16 v[64:79], v[112:115], v[116:119], v[64:79]
    ds_read_b64_tr_b16 v[92:93], v151 offset:12288
    ds_read_b64_tr_b16 v[94:95], v151 offset:13312
    s_waitcnt lgkmcnt(9)
    v_mfma_f32_32x32x16_bf16 v[16:31], v[120:123], v[136:139], v[16:31]
    s_barrier
    ds_read_b128 v[116:119], v140 offset:32768
    ds_read_b64_tr_b16 v[100:101], v148 offset:32768
    ds_read_b64_tr_b16 v[102:103], v148 offset:33792
    v_mfma_f32_32x32x16_bf16 v[32:47], v[124:127], v[136:139], v[32:47]
    ds_read_b64_tr_b16 v[104:105], v149 offset:32768
    ds_read_b64_tr_b16 v[106:107], v149 offset:33792
    v_mfma_f32_32x32x16_bf16 v[48:63], v[128:131], v[136:139], v[48:63]
    ds_read_b64_tr_b16 v[108:109], v150 offset:32768
    ds_read_b64_tr_b16 v[110:111], v150 offset:33792
    v_mfma_f32_32x32x16_bf16 v[64:79], v[132:135], v[136:139], v[64:79]
    ds_read_b64_tr_b16 v[112:113], v151 offset:32768
    ds_read_b64_tr_b16 v[114:115], v151 offset:33792
    s_waitcnt lgkmcnt(9)
    v_mfma_f32_32x32x16_bf16 v[16:31], v[80:83], v[96:99], v[16:31]
    ds_read_b128 v[136:139], v141 offset:32768
    ds_read_b64_tr_b16 v[120:121], v148 offset:36864
    ds_read_b64_tr_b16 v[122:123], v148 offset:37888
    v_mfma_f32_32x32x16_bf16 v[32:47], v[84:87], v[96:99], v[32:47]
    ds_read_b64_tr_b16 v[124:125], v149 offset:36864
    ds_read_b64_tr_b16 v[126:127], v149 offset:37888
    v_mfma_f32_32x32x16_bf16 v[48:63], v[88:91], v[96:99], v[48:63]
    ds_read_b64_tr_b16 v[128:129], v150 offset:36864
    ds_read_b64_tr_b16 v[130:131], v150 offset:37888
    v_mfma_f32_32x32x16_bf16 v[64:79], v[92:95], v[96:99], v[64:79]
    ds_read_b64_tr_b16 v[132:133], v151 offset:36864
    ds_read_b64_tr_b16 v[134:135], v151 offset:37888
    s_waitcnt lgkmcnt(9)
    v_mfma_f32_32x32x16_bf16 v[16:31], v[100:103], v[116:119], v[16:31]
    ds_read_b128 v[96:99], v142 offset:32768
    ds_read_b64_tr_b16 v[80:81], v148 offset:40960
    ds_read_b64_tr_b16 v[82:83], v148 offset:41984
    v_mfma_f32_32x32x16_bf16 v[32:47], v[104:107], v[116:119], v[32:47]
    ds_read_b64_tr_b16 v[84:85], v149 offset:40960
    ds_read_b64_tr_b16 v[86:87], v149 offset:41984
    v_mfma_f32_32x32x16_bf16 v[48:63], v[108:111], v[116:119], v[48:63]
    ds_read_b64_tr_b16 v[88:89], v150 offset:40960
    ds_read_b64_tr_b16 v[90:91], v150 offset:41984
    v_mfma_f32_32x32x16_bf16 v[64:79], v[112:115], v[116:119], v[64:79]
    ds_read_b64_tr_b16 v[92:93], v151 offset:40960
    ds_read_b64_tr_b16 v[94:95], v151 offset:41984
    s_waitcnt lgkmcnt(9)
    v_mfma_f32_32x32x16_bf16 v[16:31], v[120:123], v[136:139], v[16:31]
    ds_read_b128 v[116:119], v143 offset:32768
    ds_read_b64_tr_b16 v[100:101], v148 offset:45056
    ds_read_b64_tr_b16 v[102:103], v148 offset:46080
    v_mfma_f32_32x32x16_bf16 v[32:47], v[124:127], v[136:139], v[32:47]
    ds_read_b64_tr_b16 v[104:105], v149 offset:45056
    ds_read_b64_tr_b16 v[106:107], v149 offset:46080
    v_mfma_f32_32x32x16_bf16 v[48:63], v[128:131], v[136:139], v[48:63]
    ds_read_b64_tr_b16 v[108:109], v150 offset:45056
    ds_read_b64_tr_b16 v[110:111], v150 offset:46080
    v_mfma_f32_32x32x16_bf16 v[64:79], v[132:135], v[136:139], v[64:79]
    ds_read_b64_tr_b16 v[112:113], v151 offset:45056
    ds_read_b64_tr_b16 v[114:115], v151 offset:46080
    s_waitcnt lgkmcnt(9)
    v_mfma_f32_32x32x16_bf16 v[16:31], v[80:83], v[96:99], v[16:31]
    s_barrier
    ds_read_b128 v[136:139], v144 offset:0
    ds_read_b64_tr_b16 v[120:121], v152 offset:0
    ds_read_b64_tr_b16 v[122:123], v152 offset:1024
    v_mfma_f32_32x32x16_bf16 v[32:47], v[84:87], v[96:99], v[32:47]
    ds_read_b64_tr_b16 v[124:125], v153 offset:0
    ds_read_b64_tr_b16 v[126:127], v153 offset:1024
    v_mfma_f32_32x32x16_bf16 v[48:63], v[88:91], v[96:99], v[48:63]
    ds_read_b64_tr_b16 v[128:129], v154 offset:0
    ds_read_b64_tr_b16 v[130:131], v154 offset:1024
    v_mfma_f32_32x32x16_bf16 v[64:79], v[92:95], v[96:99], v[64:79]
    ds_read_b64_tr_b16 v[132:133], v155 offset:0
    ds_read_b64_tr_b16 v[134:135], v155 offset:1024
    s_waitcnt lgkmcnt(9)
    v_mfma_f32_32x32x16_bf16 v[16:31], v[100:103], v[116:119], v[16:31]
    ds_read_b128 v[96:99], v145 offset:0
    ds_read_b64_tr_b16 v[80:81], v152 offset:4096
    ds_read_b64_tr_b16 v[82:83], v152 offset:5120
    v_mfma_f32_32x32x16_bf16 v[32:47], v[104:107], v[116:119], v[32:47]
    ds_read_b64_tr_b16 v[84:85], v153 offset:4096
    ds_read_b64_tr_b16 v[86:87], v153 offset:5120
    v_mfma_f32_32x32x16_bf16 v[48:63], v[108:111], v[116:119], v[48:63]
    ds_read_b64_tr_b16 v[88:89], v154 offset:4096
    ds_read_b64_tr_b16 v[90:91], v154 offset:5120
    v_mfma_f32_32x32x16_bf16 v[64:79], v[112:115], v[116:119], v[64:79]
    ds_read_b64_tr_b16 v[92:93], v155 offset:4096
    ds_read_b64_tr_b16 v[94:95], v155 offset:5120
    s_waitcnt lgkmcnt(9)
    v_mfma_f32_32x32x16_bf16 v[16:31], v[120:123], v[136:139], v[16:31]
    ds_read_b128 v[116:119], v146 offset:0
    ds_read_b64_tr_b16 v[100:101], v152 offset:8192
    ds_read_b64_tr_b16 v[102:103], v152 offset:9216
    v_mfma_f32_32x32x16_bf16 v[32:47], v[124:127], v[136:139], v[32:47]
    ds_read_b64_tr_b16 v[104:105], v153 offset:8192
    ds_read_b64_tr_b16 v[106:107], v153 offset:9216
    v_mfma_f32_32x32x16_bf16 v[48:63], v[128:131], v[136:139], v[48:63]
    ds_read_b64_tr_b16 v[108:109], v154 offset:8192
    ds_read_b64_tr_b16 v[110:111], v154 offset:9216
    v_mfma_f32_32x32x16_bf16 v[64:79], v[132:135], v[136:139], v[64:79]
    ds_read_b64_tr_b16 v[112:113], v155 offset:8192
    ds_read_b64_tr_b16 v[114:115], v155 offset:9216
    s_waitcnt lgkmcnt(9)
    v_mfma_f32_32x32x16_bf16 v[16:31], v[80:83], v[96:99], v[16:31]
    ds_read_b128 v[136:139], v147 offset:0
    ds_read_b64_tr_b16 v[120:121], v152 offset:12288
    ds_read_b64_tr_b16 v[122:123], v152 offset:13312
    v_mfma_f32_32x32x16_bf16 v[32:47], v[84:87], v[96:99], v[32:47]
    ds_read_b64_tr_b16 v[124:125], v153 offset:12288
    ds_read_b64_tr_b16 v[126:127], v153 offset:13312
    v_mfma_f32_32x32x16_bf16 v[48:63], v[88:91], v[96:99], v[48:63]
    ds_read_b64_tr_b16 v[128:129], v154 offset:12288
    ds_read_b64_tr_b16 v[130:131], v154 offset:13312
    v_mfma_f32_32x32x16_bf16 v[64:79], v[92:95], v[96:99], v[64:79]
    ds_read_b64_tr_b16 v[132:133], v155 offset:12288
    ds_read_b64_tr_b16 v[134:135], v155 offset:13312
    s_waitcnt lgkmcnt(9)
    v_mfma_f32_32x32x16_bf16 v[16:31], v[100:103], v[116:119], v[16:31]
    s_barrier
    ds_read_b128 v[96:99], v144 offset:32768
    ds_read_b64_tr_b16 v[80:81], v152 offset:32768
    ds_read_b64_tr_b16 v[82:83], v152 offset:33792
    v_mfma_f32_32x32x16_bf16 v[32:47], v[104:107], v[116:119], v[32:47]
    ds_read_b64_tr_b16 v[84:85], v153 offset:32768
    ds_read_b64_tr_b16 v[86:87], v153 offset:33792
    v_mfma_f32_32x32x16_bf16 v[48:63], v[108:111], v[116:119], v[48:63]
    ds_read_b64_tr_b16 v[88:89], v154 offset:32768
    ds_read_b64_tr_b16 v[90:91], v154 offset:33792
    v_mfma_f32_32x32x16_bf16 v[64:79], v[112:115], v[116:119], v[64:79]
    ds_read_b64_tr_b16 v[92:93], v155 offset:32768
    ds_read_b64_tr_b16 v[94:95], v155 offset:33792
    s_waitcnt lgkmcnt(9)
    v_mfma_f32_32x32x16_bf16 v[16:31], v[120:123], v[136:139], v[16:31]
    ds_read_b128 v[116:119], v145 offset:32768
    ds_read_b64_tr_b16 v[100:101], v152 offset:36864
    ds_read_b64_tr_b16 v[102:103], v152 offset:37888
    v_mfma_f32_32x32x16_bf16 v[32:47], v[124:127], v[136:139], v[32:47]
    ds_read_b64_tr_b16 v[104:105], v153 offset:36864
    ds_read_b64_tr_b16 v[106:107], v153 offset:37888
    v_mfma_f32_32x32x16_bf16 v[48:63], v[128:131], v[136:139], v[48:63]
    ds_read_b64_tr_b16 v[108:109], v154 offset:36864
    ds_read_b64_tr_b16 v[110:111], v154 offset:37888
    v_mfma_f32_32x32x16_bf16 v[64:79], v[132:135], v[136:139], v[64:79]
    ds_read_b64_tr_b16 v[112:113], v155 offset:36864
    ds_read_b64_tr_b16 v[114:115], v155 offset:37888
    s_waitcnt lgkmcnt(9)
    v_mfma_f32_32x32x16_bf16 v[16:31], v[80:83], v[96:99], v[16:31]
    ds_read_b128 v[136:139], v146 offset:32768
    ds_read_b64_tr_b16 v[120:121], v152 offset:40960
    ds_read_b64_tr_b16 v[122:123], v152 offset:41984
    v_mfma_f32_32x32x16_bf16 v[32:47], v[84:87], v[96:99], v[32:47]
    ds_read_b64_tr_b16 v[124:125], v153 offset:40960
    ds_read_b64_tr_b16 v[126:127], v153 offset:41984
    v_mfma_f32_32x32x16_bf16 v[48:63], v[88:91], v[96:99], v[48:63]
    ds_read_b64_tr_b16 v[128:129], v154 offset:40960
    ds_read_b64_tr_b16 v[130:131], v154 offset:41984
    v_mfma_f32_32x32x16_bf16 v[64:79], v[92:95], v[96:99], v[64:79]
    ds_read_b64_tr_b16 v[132:133], v155 offset:40960
    ds_read_b64_tr_b16 v[134:135], v155 offset:41984
    s_waitcnt lgkmcnt(9)
    v_mfma_f32_32x32x16_bf16 v[16:31], v[100:103], v[116:119], v[16:31]
    ds_read_b128 v[96:99], v147 offset:32768
    ds_read_b64_tr_b16 v[80:81], v152 offset:45056
    ds_read_b64_tr_b16 v[82:83], v152 offset:46080
    v_mfma_f32_32x32x16_bf16 v[32:47], v[104:107], v[116:119], v[32:47]
    ds_read_b64_tr_b16 v[84:85], v153 offset:45056
    ds_read_b64_tr_b16 v[86:87], v153 offset:46080
    v_mfma_f32_32x32x16_bf16 v[48:63], v[108:111], v[116:119], v[48:63]
    ds_read_b64_tr_b16 v[88:89], v154 offset:45056
    ds_read_b64_tr_b16 v[90:91], v154 offset:46080
    v_mfma_f32_32x32x16_bf16 v[64:79], v[112:115], v[116:119], v[64:79]
    ds_read_b64_tr_b16 v[92:93], v155 offset:45056
    ds_read_b64_tr_b16 v[94:95], v155 offset:46080
    s_waitcnt lgkmcnt(9)
    v_mfma_f32_32x32x16_bf16 v[16:31], v[120:123], v[136:139], v[16:31]
    s_barrier
    ds_read_b128 v[116:119], v140 offset:0
    ds_read_b64_tr_b16 v[100:101], v148 offset:0
    ds_read_b64_tr_b16 v[102:103], v148 offset:1024
    v_mfma_f32_32x32x16_bf16 v[32:47], v[124:127], v[136:139], v[32:47]
    ds_read_b64_tr_b16 v[104:105], v149 offset:0
    ds_read_b64_tr_b16 v[106:107], v149 offset:1024
    v_mfma_f32_32x32x16_bf16 v[48:63], v[128:131], v[136:139], v[48:63]
    ds_read_b64_tr_b16 v[108:109], v150 offset:0
    ds_read_b64_tr_b16 v[110:111], v150 offset:1024
    v_mfma_f32_32x32x16_bf16 v[64:79], v[132:135], v[136:139], v[64:79]
    ds_read_b64_tr_b16 v[112:113], v151 offset:0
    ds_read_b64_tr_b16 v[114:115], v151 offset:1024
    s_waitcnt lgkmcnt(9)
    v_mfma_f32_32x32x16_bf16 v[16:31], v[80:83], v[96:99], v[16:31]
    ds_read_b128 v[136:139], v141 offset:0
    ds_read_b64_tr_b16 v[120:121], v148 offset:4096
    ds_read_b64_tr_b16 v[122:123], v148 offset:5120
    v_mfma_f32_32x32x16_bf16 v[32:47], v[84:87], v[96:99], v[32:47]
    ds_read_b64_tr_b16 v[124:125], v149 offset:4096
    ds_read_b64_tr_b16 v[126:127], v149 offset:5120
    v_mfma_f32_32x32x16_bf16 v[48:63], v[88:91], v[96:99], v[48:63]
    ds_read_b64_tr_b16 v[128:129], v150 offset:4096
    ds_read_b64_tr_b16 v[130:131], v150 offset:5120
    v_mfma_f32_32x32x16_bf16 v[64:79], v[92:95], v[96:99], v[64:79]
    ds_read_b64_tr_b16 v[132:133], v151 offset:4096
    ds_read_b64_tr_b16 v[134:135], v151 offset:5120
    s_waitcnt lgkmcnt(9)
    v_mfma_f32_32x32x16_bf16 v[16:31], v[100:103], v[116:119], v[16:31]
    ds_read_b128 v[96:99], v142 offset:0
    ds_read_b64_tr_b16 v[80:81], v148 offset:8192
    ds_read_b64_tr_b16 v[82:83], v148 offset:9216
    v_mfma_f32_32x32x16_bf16 v[32:47], v[104:107], v[116:119], v[32:47]
    ds_read_b64_tr_b16 v[84:85], v149 offset:8192
    ds_read_b64_tr_b16 v[86:87], v149 offset:9216
    v_mfma_f32_32x32x16_bf16 v[48:63], v[108:111], v[116:119], v[48:63]
    ds_read_b64_tr_b16 v[88:89], v150 offset:8192
    ds_read_b64_tr_b16 v[90:91], v150 offset:9216
    v_mfma_f32_32x32x16_bf16 v[64:79], v[112:115], v[116:119], v[64:79]
    ds_read_b64_tr_b16 v[92:93], v151 offset:8192
    ds_read_b64_tr_b16 v[94:95], v151 offset:9216
    s_waitcnt lgkmcnt(9)
    v_mfma_f32_32x32x16_bf16 v[16:31], v[120:123], v[136:139], v[16:31]
    ds_read_b128 v[116:119], v143 offset:0
    ds_read_b64_tr_b16 v[100:101], v148 offset:12288
    ds_read_b64_tr_b16 v[102:103], v148 offset:13312
    v_mfma_f32_32x32x16_bf16 v[32:47], v[124:127], v[136:139], v[32:47]
    ds_read_b64_tr_b16 v[104:105], v149 offset:12288
    ds_read_b64_tr_b16 v[106:107], v149 offset:13312
    v_mfma_f32_32x32x16_bf16 v[48:63], v[128:131], v[136:139], v[48:63]
    ds_read_b64_tr_b16 v[108:109], v150 offset:12288
    ds_read_b64_tr_b16 v[110:111], v150 offset:13312
    v_mfma_f32_32x32x16_bf16 v[64:79], v[132:135], v[136:139], v[64:79]
    ds_read_b64_tr_b16 v[112:113], v151 offset:12288
    ds_read_b64_tr_b16 v[114:115], v151 offset:13312
    s_waitcnt lgkmcnt(9)
    v_mfma_f32_32x32x16_bf16 v[16:31], v[80:83], v[96:99], v[16:31]
    s_barrier
    ds_read_b128 v[136:139], v140 offset:32768
    ds_read_b64_tr_b16 v[120:121], v148 offset:32768
    ds_read_b64_tr_b16 v[122:123], v148 offset:33792
    v_mfma_f32_32x32x16_bf16 v[32:47], v[84:87], v[96:99], v[32:47]
    ds_read_b64_tr_b16 v[124:125], v149 offset:32768
    ds_read_b64_tr_b16 v[126:127], v149 offset:33792
    v_mfma_f32_32x32x16_bf16 v[48:63], v[88:91], v[96:99], v[48:63]
    ds_read_b64_tr_b16 v[128:129], v150 offset:32768
    ds_read_b64_tr_b16 v[130:131], v150 offset:33792
    v_mfma_f32_32x32x16_bf16 v[64:79], v[92:95], v[96:99], v[64:79]
    ds_read_b64_tr_b16 v[132:133], v151 offset:32768
    ds_read_b64_tr_b16 v[134:135], v151 offset:33792
    s_waitcnt lgkmcnt(9)
    v_mfma_f32_32x32x16_bf16 v[16:31], v[100:103], v[116:119], v[16:31]
    ds_read_b128 v[96:99], v141 offset:32768
    ds_read_b64_tr_b16 v[80:81], v148 offset:36864
    ds_read_b64_tr_b16 v[82:83], v148 offset:37888
    v_mfma_f32_32x32x16_bf16 v[32:47], v[104:107], v[116:119], v[32:47]
    ds_read_b64_tr_b16 v[84:85], v149 offset:36864
    ds_read_b64_tr_b16 v[86:87], v149 offset:37888
    v_mfma_f32_32x32x16_bf16 v[48:63], v[108:111], v[116:119], v[48:63]
    ds_read_b64_tr_b16 v[88:89], v150 offset:36864
    ds_read_b64_tr_b16 v[90:91], v150 offset:37888
    v_mfma_f32_32x32x16_bf16 v[64:79], v[112:115], v[116:119], v[64:79]
    ds_read_b64_tr_b16 v[92:93], v151 offset:36864
    ds_read_b64_tr_b16 v[94:95], v151 offset:37888
    s_waitcnt lgkmcnt(9)
    v_mfma_f32_32x32x16_bf16 v[16:31], v[120:123], v[136:139], v[16:31]
    ds_read_b128 v[116:119], v142 offset:32768
    ds_read_b64_tr_b16 v[100:101], v148 offset:40960
    ds_read_b64_tr_b16 v[102:103], v148 offset:41984
    v_mfma_f32_32x32x16_bf16 v[32:47], v[124:127], v[136:139], v[32:47]
    ds_read_b64_tr_b16 v[104:105], v149 offset:40960
    ds_read_b64_tr_b16 v[106:107], v149 offset:41984
    v_mfma_f32_32x32x16_bf16 v[48:63], v[128:131], v[136:139], v[48:63]
    ds_read_b64_tr_b16 v[108:109], v150 offset:40960
    ds_read_b64_tr_b16 v[110:111], v150 offset:41984
    v_mfma_f32_32x32x16_bf16 v[64:79], v[132:135], v[136:139], v[64:79]
    ds_read_b64_tr_b16 v[112:113], v151 offset:40960
    ds_read_b64_tr_b16 v[114:115], v151 offset:41984
    s_waitcnt lgkmcnt(9)
    v_mfma_f32_32x32x16_bf16 v[16:31], v[80:83], v[96:99], v[16:31]
    ds_read_b128 v[136:139], v143 offset:32768
    ds_read_b64_tr_b16 v[120:121], v148 offset:45056
    ds_read_b64_tr_b16 v[122:123], v148 offset:46080
    v_mfma_f32_32x32x16_bf16 v[32:47], v[84:87], v[96:99], v[32:47]
    ds_read_b64_tr_b16 v[124:125], v149 offset:45056
    ds_read_b64_tr_b16 v[126:127], v149 offset:46080
    v_mfma_f32_32x32x16_bf16 v[48:63], v[88:91], v[96:99], v[48:63]
    ds_read_b64_tr_b16 v[128:129], v150 offset:45056
    ds_read_b64_tr_b16 v[130:131], v150 offset:46080
    v_mfma_f32_32x32x16_bf16 v[64:79], v[92:95], v[96:99], v[64:79]
    ds_read_b64_tr_b16 v[132:133], v151 offset:45056
    ds_read_b64_tr_b16 v[134:135], v151 offset:46080
    s_waitcnt lgkmcnt(9)
    v_mfma_f32_32x32x16_bf16 v[16:31], v[100:103], v[116:119], v[16:31]
    s_barrier
    ds_read_b128 v[96:99], v144 offset:0
    ds_read_b64_tr_b16 v[80:81], v152 offset:0
    ds_read_b64_tr_b16 v[82:83], v152 offset:1024
    v_mfma_f32_32x32x16_bf16 v[32:47], v[104:107], v[116:119], v[32:47]
    ds_read_b64_tr_b16 v[84:85], v153 offset:0
    ds_read_b64_tr_b16 v[86:87], v153 offset:1024
    v_mfma_f32_32x32x16_bf16 v[48:63], v[108:111], v[116:119], v[48:63]
    ds_read_b64_tr_b16 v[88:89], v154 offset:0
    ds_read_b64_tr_b16 v[90:91], v154 offset:1024
    v_mfma_f32_32x32x16_bf16 v[64:79], v[112:115], v[116:119], v[64:79]
    ds_read_b64_tr_b16 v[92:93], v155 offset:0
    ds_read_b64_tr_b16 v[94:95], v155 offset:1024
    s_waitcnt lgkmcnt(9)
    v_mfma_f32_32x32x16_bf16 v[16:31], v[120:123], v[136:139], v[16:31]
    ds_read_b128 v[116:119], v145 offset:0
    ds_read_b64_tr_b16 v[100:101], v152 offset:4096
    ds_read_b64_tr_b16 v[102:103], v152 offset:5120
    v_mfma_f32_32x32x16_bf16 v[32:47], v[124:127], v[136:139], v[32:47]
    ds_read_b64_tr_b16 v[104:105], v153 offset:4096
    ds_read_b64_tr_b16 v[106:107], v153 offset:5120
    v_mfma_f32_32x32x16_bf16 v[48:63], v[128:131], v[136:139], v[48:63]
    ds_read_b64_tr_b16 v[108:109], v154 offset:4096
    ds_read_b64_tr_b16 v[110:111], v154 offset:5120
    v_mfma_f32_32x32x16_bf16 v[64:79], v[132:135], v[136:139], v[64:79]
    ds_read_b64_tr_b16 v[112:113], v155 offset:4096
    ds_read_b64_tr_b16 v[114:115], v155 offset:5120
    s_waitcnt lgkmcnt(9)
    v_mfma_f32_32x32x16_bf16 v[16:31], v[80:83], v[96:99], v[16:31]
    ds_read_b128 v[136:139], v146 offset:0
    ds_read_b64_tr_b16 v[120:121], v152 offset:8192
    ds_read_b64_tr_b16 v[122:123], v152 offset:9216
    v_mfma_f32_32x32x16_bf16 v[32:47], v[84:87], v[96:99], v[32:47]
    ds_read_b64_tr_b16 v[124:125], v153 offset:8192
    ds_read_b64_tr_b16 v[126:127], v153 offset:9216
    v_mfma_f32_32x32x16_bf16 v[48:63], v[88:91], v[96:99], v[48:63]
    ds_read_b64_tr_b16 v[128:129], v154 offset:8192
    ds_read_b64_tr_b16 v[130:131], v154 offset:9216
    v_mfma_f32_32x32x16_bf16 v[64:79], v[92:95], v[96:99], v[64:79]
    ds_read_b64_tr_b16 v[132:133], v155 offset:8192
    ds_read_b64_tr_b16 v[134:135], v155 offset:9216
    s_waitcnt lgkmcnt(9)
    v_mfma_f32_32x32x16_bf16 v[16:31], v[100:103], v[116:119], v[16:31]
    ds_read_b128 v[96:99], v147 offset:0
    ds_read_b64_tr_b16 v[80:81], v152 offset:12288
    ds_read_b64_tr_b16 v[82:83], v152 offset:13312
    v_mfma_f32_32x32x16_bf16 v[32:47], v[104:107], v[116:119], v[32:47]
    ds_read_b64_tr_b16 v[84:85], v153 offset:12288
    ds_read_b64_tr_b16 v[86:87], v153 offset:13312
    v_mfma_f32_32x32x16_bf16 v[48:63], v[108:111], v[116:119], v[48:63]
    ds_read_b64_tr_b16 v[88:89], v154 offset:12288
    ds_read_b64_tr_b16 v[90:91], v154 offset:13312
    v_mfma_f32_32x32x16_bf16 v[64:79], v[112:115], v[116:119], v[64:79]
    ds_read_b64_tr_b16 v[92:93], v155 offset:12288
    ds_read_b64_tr_b16 v[94:95], v155 offset:13312
    s_waitcnt lgkmcnt(9)
    v_mfma_f32_32x32x16_bf16 v[16:31], v[120:123], v[136:139], v[16:31]
    s_barrier
    ds_read_b128 v[116:119], v144 offset:32768
    ds_read_b64_tr_b16 v[100:101], v152 offset:32768
    ds_read_b64_tr_b16 v[102:103], v152 offset:33792
    v_mfma_f32_32x32x16_bf16 v[32:47], v[124:127], v[136:139], v[32:47]
    ds_read_b64_tr_b16 v[104:105], v153 offset:32768
    ds_read_b64_tr_b16 v[106:107], v153 offset:33792
    v_mfma_f32_32x32x16_bf16 v[48:63], v[128:131], v[136:139], v[48:63]
    ds_read_b64_tr_b16 v[108:109], v154 offset:32768
    ds_read_b64_tr_b16 v[110:111], v154 offset:33792
    v_mfma_f32_32x32x16_bf16 v[64:79], v[132:135], v[136:139], v[64:79]
    ds_read_b64_tr_b16 v[112:113], v155 offset:32768
    ds_read_b64_tr_b16 v[114:115], v155 offset:33792
    s_waitcnt lgkmcnt(9)
    v_mfma_f32_32x32x16_bf16 v[16:31], v[80:83], v[96:99], v[16:31]
    ds_read_b128 v[136:139], v145 offset:32768
    ds_read_b64_tr_b16 v[120:121], v152 offset:36864
    ds_read_b64_tr_b16 v[122:123], v152 offset:37888
    v_mfma_f32_32x32x16_bf16 v[32:47], v[84:87], v[96:99], v[32:47]
    ds_read_b64_tr_b16 v[124:125], v153 offset:36864
    ds_read_b64_tr_b16 v[126:127], v153 offset:37888
    v_mfma_f32_32x32x16_bf16 v[48:63], v[88:91], v[96:99], v[48:63]
    ds_read_b64_tr_b16 v[128:129], v154 offset:36864
    ds_read_b64_tr_b16 v[130:131], v154 offset:37888
    v_mfma_f32_32x32x16_bf16 v[64:79], v[92:95], v[96:99], v[64:79]
    ds_read_b64_tr_b16 v[132:133], v155 offset:36864
    ds_read_b64_tr_b16 v[134:135], v155 offset:37888
    s_waitcnt lgkmcnt(9)
    v_mfma_f32_32x32x16_bf16 v[16:31], v[100:103], v[116:119], v[16:31]
    ds_read_b128 v[96:99], v146 offset:32768
    ds_read_b64_tr_b16 v[80:81], v152 offset:40960
    ds_read_b64_tr_b16 v[82:83], v152 offset:41984
    v_mfma_f32_32x32x16_bf16 v[32:47], v[104:107], v[116:119], v[32:47]
    ds_read_b64_tr_b16 v[84:85], v153 offset:40960
    ds_read_b64_tr_b16 v[86:87], v153 offset:41984
    v_mfma_f32_32x32x16_bf16 v[48:63], v[108:111], v[116:119], v[48:63]
    ds_read_b64_tr_b16 v[88:89], v154 offset:40960
    ds_read_b64_tr_b16 v[90:91], v154 offset:41984
    v_mfma_f32_32x32x16_bf16 v[64:79], v[112:115], v[116:119], v[64:79]
    ds_read_b64_tr_b16 v[92:93], v155 offset:40960
    ds_read_b64_tr_b16 v[94:95], v155 offset:41984
    s_waitcnt lgkmcnt(9)
    v_mfma_f32_32x32x16_bf16 v[16:31], v[120:123], v[136:139], v[16:31]
    ds_read_b128 v[116:119], v147 offset:32768
    ds_read_b64_tr_b16 v[100:101], v152 offset:45056
    ds_read_b64_tr_b16 v[102:103], v152 offset:46080
    v_mfma_f32_32x32x16_bf16 v[32:47], v[124:127], v[136:139], v[32:47]
    ds_read_b64_tr_b16 v[104:105], v153 offset:45056
    ds_read_b64_tr_b16 v[106:107], v153 offset:46080
    v_mfma_f32_32x32x16_bf16 v[48:63], v[128:131], v[136:139], v[48:63]
    ds_read_b64_tr_b16 v[108:109], v154 offset:45056
    ds_read_b64_tr_b16 v[110:111], v154 offset:46080
    v_mfma_f32_32x32x16_bf16 v[64:79], v[132:135], v[136:139], v[64:79]
    ds_read_b64_tr_b16 v[112:113], v155 offset:45056
    ds_read_b64_tr_b16 v[114:115], v155 offset:46080
    s_waitcnt lgkmcnt(9)
    v_mfma_f32_32x32x16_bf16 v[16:31], v[80:83], v[96:99], v[16:31]
    s_barrier
    s_setprio 2
    ds_read_b128 v[136:139], v140 offset:0
    ds_read_b64_tr_b16 v[120:121], v148 offset:0
    ds_read_b64_tr_b16 v[122:123], v148 offset:1024
    v_mfma_f32_32x32x16_bf16 v[32:47], v[84:87], v[96:99], v[32:47]
    ds_read_b64_tr_b16 v[124:125], v149 offset:0
    ds_read_b64_tr_b16 v[126:127], v149 offset:1024
    v_mfma_f32_32x32x16_bf16 v[48:63], v[88:91], v[96:99], v[48:63]
    ds_read_b64_tr_b16 v[128:129], v150 offset:0
    ds_read_b64_tr_b16 v[130:131], v150 offset:1024
    v_mfma_f32_32x32x16_bf16 v[64:79], v[92:95], v[96:99], v[64:79]
    ds_read_b64_tr_b16 v[132:133], v151 offset:0
    ds_read_b64_tr_b16 v[134:135], v151 offset:1024
    s_waitcnt lgkmcnt(9)
    v_mfma_f32_32x32x16_bf16 v[16:31], v[100:103], v[116:119], v[16:31]
    ds_read_b128 v[96:99], v141 offset:0
    ds_read_b64_tr_b16 v[80:81], v148 offset:4096
    ds_read_b64_tr_b16 v[82:83], v148 offset:5120
    v_mfma_f32_32x32x16_bf16 v[32:47], v[104:107], v[116:119], v[32:47]
    ds_read_b64_tr_b16 v[84:85], v149 offset:4096
    ds_read_b64_tr_b16 v[86:87], v149 offset:5120
    v_mfma_f32_32x32x16_bf16 v[48:63], v[108:111], v[116:119], v[48:63]
    ds_read_b64_tr_b16 v[88:89], v150 offset:4096
    ds_read_b64_tr_b16 v[90:91], v150 offset:5120
    v_mfma_f32_32x32x16_bf16 v[64:79], v[112:115], v[116:119], v[64:79]
    ds_read_b64_tr_b16 v[92:93], v151 offset:4096
    ds_read_b64_tr_b16 v[94:95], v151 offset:5120
    s_waitcnt lgkmcnt(9)
    v_mfma_f32_32x32x16_bf16 v[16:31], v[120:123], v[136:139], v[16:31]
    ds_read_b128 v[116:119], v142 offset:0
    ds_read_b64_tr_b16 v[100:101], v148 offset:8192
    ds_read_b64_tr_b16 v[102:103], v148 offset:9216
    v_mfma_f32_32x32x16_bf16 v[32:47], v[124:127], v[136:139], v[32:47]
    ds_read_b64_tr_b16 v[104:105], v149 offset:8192
    ds_read_b64_tr_b16 v[106:107], v149 offset:9216
    v_mfma_f32_32x32x16_bf16 v[48:63], v[128:131], v[136:139], v[48:63]
    ds_read_b64_tr_b16 v[108:109], v150 offset:8192
    ds_read_b64_tr_b16 v[110:111], v150 offset:9216
    v_mfma_f32_32x32x16_bf16 v[64:79], v[132:135], v[136:139], v[64:79]
    ds_read_b64_tr_b16 v[112:113], v151 offset:8192
    ds_read_b64_tr_b16 v[114:115], v151 offset:9216
    s_waitcnt lgkmcnt(9)
    v_mfma_f32_32x32x16_bf16 v[16:31], v[80:83], v[96:99], v[16:31]
    ds_read_b128 v[136:139], v143 offset:0
    ds_read_b64_tr_b16 v[120:121], v148 offset:12288
    ds_read_b64_tr_b16 v[122:123], v148 offset:13312
    ds_read_b64_tr_b16 v[124:125], v149 offset:12288
    ds_read_b64_tr_b16 v[126:127], v149 offset:13312
    v_mfma_f32_32x32x16_bf16 v[32:47], v[84:87], v[96:99], v[32:47]
    ds_read_b64_tr_b16 v[128:129], v150 offset:12288
    ds_read_b64_tr_b16 v[130:131], v150 offset:13312
    ds_read_b64_tr_b16 v[132:133], v151 offset:12288
    ds_read_b64_tr_b16 v[134:135], v151 offset:13312
    s_waitcnt lgkmcnt(9)
    v_mfma_f32_32x32x16_bf16 v[16:31], v[100:103], v[116:119], v[16:31]
    v_mfma_f32_32x32x16_bf16 v[32:47], v[104:107], v[116:119], v[32:47]
    v_mfma_f32_32x32x16_bf16 v[48:63], v[88:91], v[96:99], v[48:63]
    s_waitcnt lgkmcnt(0)
    v_mfma_f32_32x32x16_bf16 v[16:31], v[120:123], v[136:139], v[16:31]
    s_mov_b64 exec, 1
    ds_add_u32 v3, v1 offset:4
    s_mov_b64 exec, -1
    v_mfma_f32_32x32x16_bf16 v[32:47], v[124:127], v[136:139], v[32:47]
    v_mfma_f32_32x32x16_bf16 v[48:63], v[108:111], v[116:119], v[48:63]
    s_nop 6
    s_cmp_gt_u32 s42, 4
    s_cbranch_scc1 G_NS_8
    v_mul_f32 v16, s40, v16
    v_mul_f32 v17, s40, v17
    v_mul_f32 v18, s40, v18
    v_mul_f32 v19, s40, v19
    v_mul_f32 v20, s40, v20
    v_mul_f32 v21, s40, v21
    v_mul_f32 v22, s40, v22
    v_mul_f32 v23, s40, v23
    v_mul_f32 v24, s40, v24
    v_mul_f32 v25, s40, v25
    v_mul_f32 v26, s40, v26
    v_mul_f32 v27, s40, v27
    v_mul_f32 v28, s40, v28
    v_mul_f32 v29, s40, v29
    v_mul_f32 v30, s40, v30
    v_mul_f32 v31, s40, v31
G_NS_8:
    v_mfma_f32_32x32x16_bf16 v[48:63], v[128:131], v[136:139], v[48:63]
    v_cvt_pk_bf16_f32 v16, v16, v17
    v_cvt_pk_bf16_f32 v17, v18, v19
    v_cvt_pk_bf16_f32 v18, v20, v21
    v_cvt_pk_bf16_f32 v19, v22, v23
    v_cvt_pk_bf16_f32 v20, v24, v25
    v_cvt_pk_bf16_f32 v21, v26, v27
    v_cvt_pk_bf16_f32 v22, v28, v29
    v_cvt_pk_bf16_f32 v23, v30, v31
    v_mfma_f32_32x32x16_bf16 v[64:79], v[92:95], v[96:99], v[64:79]
    buffer_store_dwordx2 v[16:17], v156, s[16:19], s34 offen offset:0 sc1
    buffer_store_dwordx2 v[18:19], v156, s[16:19], s34 offen offset:512 sc1
    buffer_store_dwordx2 v[20:21], v156, s[16:19], s34 offen offset:1024 sc1
    buffer_store_dwordx2 v[22:23], v156, s[16:19], s34 offen offset:1536 sc1
    s_cmp_gt_u32 s42, 4
    s_cbranch_scc1 G_NS_9
    v_mul_f32 v32, s40, v32
    v_mul_f32 v33, s40, v33
    v_mul_f32 v34, s40, v34
    v_mul_f32 v35, s40, v35
    v_mul_f32 v36, s40, v36
    v_mul_f32 v37, s40, v37
    v_mul_f32 v38, s40, v38
    v_mul_f32 v39, s40, v39
    v_mul_f32 v40, s40, v40
    v_mul_f32 v41, s40, v41
    v_mul_f32 v42, s40, v42
    v_mul_f32 v43, s40, v43
    v_mul_f32 v44, s40, v44
    v_mul_f32 v45, s40, v45
    v_mul_f32 v46, s40, v46
    v_mul_f32 v47, s40, v47
G_NS_9:
    v_mfma_f32_32x32x16_bf16 v[64:79], v[112:115], v[116:119], v[64:79]
    v_cvt_pk_bf16_f32 v32, v32, v33
    v_cvt_pk_bf16_f32 v33, v34, v35
    v_cvt_pk_bf16_f32 v34, v36, v37
    v_cvt_pk_bf16_f32 v35, v38, v39
    v_cvt_pk_bf16_f32 v36, v40, v41
    v_cvt_pk_bf16_f32 v37, v42, v43
    v_cvt_pk_bf16_f32 v38, v44, v45
    v_cvt_pk_bf16_f32 v39, v46, v47
    v_mfma_f32_32x32x16_bf16 v[64:79], v[132:135], v[136:139], v[64:79]
    buffer_store_dwordx2 v[32:33], v156, s[16:19], s34 offen offset:2048 sc1
    buffer_store_dwordx2 v[34:35], v156, s[16:19], s34 offen offset:2560 sc1
    buffer_store_dwordx2 v[36:37], v156, s[16:19], s34 offen offset:3072 sc1
    buffer_store_dwordx2 v[38:39], v156, s[16:19], s34 offen offset:3584 sc1
    s_cmp_gt_u32 s42, 3
    s_cbranch_scc1 G_NS_10
    v_pk_mul_f32 v[48:49], v[48:49], s[40:41]
    v_pk_mul_f32 v[50:51], v[50:51], s[40:41]
    v_pk_mul_f32 v[52:53], v[52:53], s[40:41]
    v_pk_mul_f32 v[54:55], v[54:55], s[40:41]
    v_pk_mul_f32 v[56:57], v[56:57], s[40:41]
    v_pk_mul_f32 v[58:59], v[58:59], s[40:41]
    v_pk_mul_f32 v[60:61], v[60:61], s[40:41]
    v_pk_mul_f32 v[62:63], v[62:63], s[40:41]
G_NS_10:
    v_cvt_pk_bf16_f32 v48, v48, v49
    v_cvt_pk_bf16_f32 v49, v50, v51
    v_cvt_pk_bf16_f32 v50, v52, v53
    v_cvt_pk_bf16_f32 v51, v54, v55
    v_cvt_pk_bf16_f32 v52, v56, v57
    v_cvt_pk_bf16_f32 v53, v58, v59
    v_cvt_pk_bf16_f32 v54, v60, v61
    v_cvt_pk_bf16_f32 v55, v62, v63
    buffer_store_dwordx2 v[48:49], v156, s[16:19], s35 offen offset:0 sc1
    buffer_store_dwordx2 v[50:51], v156, s[16:19], s35 offen offset:512 sc1
    buffer_store_dwordx2 v[52:53], v156, s[16:19], s35 offen offset:1024 sc1
    buffer_store_dwordx2 v[54:55], v156, s[16:19], s35 offen offset:1536 sc1
    s_cmp_gt_u32 s42, 3
    s_cbranch_scc1 G_NS_11
    v_pk_mul_f32 v[64:65], v[64:65], s[40:41]
    v_pk_mul_f32 v[66:67], v[66:67], s[40:41]
    v_pk_mul_f32 v[68:69], v[68:69], s[40:41]
    v_pk_mul_f32 v[70:71], v[70:71], s[40:41]
    v_pk_mul_f32 v[72:73], v[72:73], s[40:41]
    v_pk_mul_f32 v[74:75], v[74:75], s[40:41]
    v_pk_mul_f32 v[76:77], v[76:77], s[40:41]
    v_pk_mul_f32 v[78:79], v[78:79], s[40:41]
G_NS_11:
    v_cvt_pk_bf16_f32 v64, v64, v65
    v_cvt_pk_bf16_f32 v65, v66, v67
    v_cvt_pk_bf16_f32 v66, v68, v69
    v_cvt_pk_bf16_f32 v67, v70, v71
    v_cvt_pk_bf16_f32 v68, v72, v73
    v_cvt_pk_bf16_f32 v69, v74, v75
    v_cvt_pk_bf16_f32 v70, v76, v77
    v_cvt_pk_bf16_f32 v71, v78, v79
    buffer_store_dwordx2 v[64:65], v156, s[16:19], s35 offen offset:2048 sc1
    buffer_store_dwordx2 v[66:67], v156, s[16:19], s35 offen offset:2560 sc1
    buffer_store_dwordx2 v[68:69], v156, s[16:19], s35 offen offset:3072 sc1
    buffer_store_dwordx2 v[70:71], v156, s[16:19], s35 offen offset:3584 sc1
    s_branch G_PUB
G_V:
    s_waitcnt lgkmcnt(9)
    v_mfma_f32_32x32x16_bf16 v[16:31], v[96:99], v[80:83], 0
    ds_read_b128 v[136:139], v142 offset:0
    ds_read_b64_tr_b16 v[120:121], v148 offset:8192
    ds_read_b64_tr_b16 v[122:123], v148 offset:9216
    v_mfma_f32_32x32x16_bf16 v[32:47], v[96:99], v[84:87], 0
    ds_read_b64_tr_b16 v[124:125], v149 offset:8192
    ds_read_b64_tr_b16 v[126:127], v149 offset:9216
    v_mfma_f32_32x32x16_bf16 v[48:63], v[96:99], v[88:91], 0
    ds_read_b64_tr_b16 v[128:129], v150 offset:8192
    ds_read_b64_tr_b16 v[130:131], v150 offset:9216
    v_mfma_f32_32x32x16_bf16 v[64:79], v[96:99], v[92:95], 0
    ds_read_b64_tr_b16 v[132:133], v151 offset:8192
    ds_read_b64_tr_b16 v[134:135], v151 offset:9216
    s_waitcnt lgkmcnt(9)
    v_mfma_f32_32x32x16_bf16 v[16:31], v[116:119], v[100:103], v[16:31]
    ds_read_b128 v[96:99], v143 offset:0
    ds_read_b64_tr_b16 v[80:81], v148 offset:12288
    ds_read_b64_tr_b16 v[82:83], v148 offset:13312
    v_mfma_f32_32x32x16_bf16 v[32:47], v[116:119], v[104:107], v[32:47]
    ds_read_b64_tr_b16 v[84:85], v149 offset:12288
    ds_read_b64_tr_b16 v[86:87], v149 offset:13312
    v_mfma_f32_32x32x16_bf16 v[48:63], v[116:119], v[108:111], v[48:63]
    ds_read_b64_tr_b16 v[88:89], v150 offset:12288
    ds_read_b64_tr_b16 v[90:91], v150 offset:13312
    v_mfma_f32_32x32x16_bf16 v[64:79], v[116:119], v[112:115], v[64:79]
    ds_read_b64_tr_b16 v[92:93], v151 offset:12288
    ds_read_b64_tr_b16 v[94:95], v151 offset:13312
    s_waitcnt lgkmcnt(9)
    v_mfma_f32_32x32x16_bf16 v[16:31], v[136:139], v[120:123], v[16:31]
    s_barrier
    ds_read_b128 v[116:119], v140 offset:32768
    ds_read_b64_tr_b16 v[100:101], v148 offset:32768
    ds_read_b64_tr_b16 v[102:103], v148 offset:33792
    v_mfma_f32_32x32x16_bf16 v[32:47], v[136:139], v[124:127], v[32:47]
    ds_read_b64_tr_b16 v[104:105], v149 offset:32768
    ds_read_b64_tr_b16 v[106:107], v149 offset:33792
    v_mfma_f32_32x32x16_bf16 v[48:63], v[136:139], v[128:131], v[48:63]
    ds_read_b64_tr_b16 v[108:109], v150 offset:32768
    ds_read_b64_tr_b16 v[110:111], v150 offset:33792
    v_mfma_f32_32x32x16_bf16 v[64:79], v[136:139], v[132:135], v[64:79]
    ds_read_b64_tr_b16 v[112:113], v151 offset:32768
    ds_read_b64_tr_b16 v[114:115], v151 offset:33792
    s_waitcnt lgkmcnt(9)
    v_mfma_f32_32x32x16_bf16 v[16:31], v[96:99], v[80:83], v[16:31]
    ds_read_b128 v[136:139], v141 offset:32768
    ds_read_b64_tr_b16 v[120:121], v148 offset:36864
    ds_read_b64_tr_b16 v[122:123], v148 offset:37888
    v_mfma_f32_32x32x16_bf16 v[32:47], v[96:99], v[84:87], v[32:47]
    ds_read_b64_tr_b16 v[124:125], v149 offset:36864
    ds_read_b64_tr_b16 v[126:127], v149 offset:37888
    v_mfma_f32_32x32x16_bf16 v[48:63], v[96:99], v[88:91], v[48:63]
    ds_read_b64_tr_b16 v[128:129], v150 offset:36864
    ds_read_b64_tr_b16 v[130:131], v150 offset:37888
    v_mfma_f32_32x32x16_bf16 v[64:79], v[96:99], v[92:95], v[64:79]
    ds_read_b64_tr_b16 v[132:133], v151 offset:36864
    ds_read_b64_tr_b16 v[134:135], v151 offset:37888
    s_waitcnt lgkmcnt(9)
    v_mfma_f32_32x32x16_bf16 v[16:31], v[116:119], v[100:103], v[16:31]
    ds_read_b128 v[96:99], v142 offset:32768
    ds_read_b64_tr_b16 v[80:81], v148 offset:40960
    ds_read_b64_tr_b16 v[82:83], v148 offset:41984
    v_mfma_f32_32x32x16_bf16 v[32:47], v[116:119], v[104:107], v[32:47]
    ds_read_b64_tr_b16 v[84:85], v149 offset:40960
    ds_read_b64_tr_b16 v[86:87], v149 offset:41984
    v_mfma_f32_32x32x16_bf16 v[48:63], v[116:119], v[108:111], v[48:63]
    ds_read_b64_tr_b16 v[88:89], v150 offset:40960
    ds_read_b64_tr_b16 v[90:91], v150 offset:41984
    v_mfma_f32_32x32x16_bf16 v[64:79], v[116:119], v[112:115], v[64:79]
    ds_read_b64_tr_b16 v[92:93], v151 offset:40960
    ds_read_b64_tr_b16 v[94:95], v151 offset:41984
    s_waitcnt lgkmcnt(9)
    v_mfma_f32_32x32x16_bf16 v[16:31], v[136:139], v[120:123], v[16:31]
    ds_read_b128 v[116:119], v143 offset:32768
    ds_read_b64_tr_b16 v[100:101], v148 offset:45056
    ds_read_b64_tr_b16 v[102:103], v148 offset:46080
    v_mfma_f32_32x32x16_bf16 v[32:47], v[136:139], v[124:127], v[32:47]
    ds_read_b64_tr_b16 v[104:105], v149 offset:45056
    ds_read_b64_tr_b16 v[106:107], v149 offset:46080
    v_mfma_f32_32x32x16_bf16 v[48:63], v[136:139], v[128:131], v[48:63]
    ds_read_b64_tr_b16 v[108:109], v150 offset:45056
    ds_read_b64_tr_b16 v[110:111], v150 offset:46080
    v_mfma_f32_32x32x16_bf16 v[64:79], v[136:139], v[132:135], v[64:79]
    ds_read_b64_tr_b16 v[112:113], v151 offset:45056
    ds_read_b64_tr_b16 v[114:115], v151 offset:46080
    s_waitcnt lgkmcnt(9)
    v_mfma_f32_32x32x16_bf16 v[16:31], v[96:99], v[80:83], v[16:31]
    s_barrier
    ds_read_b128 v[136:139], v144 offset:0
    ds_read_b64_tr_b16 v[120:121], v152 offset:0
    ds_read_b64_tr_b16 v[122:123], v152 offset:1024
    v_mfma_f32_32x32x16_bf16 v[32:47], v[96:99], v[84:87], v[32:47]
    ds_read_b64_tr_b16 v[124:125], v153 offset:0
    ds_read_b64_tr_b16 v[126:127], v153 offset:1024
    v_mfma_f32_32x32x16_bf16 v[48:63], v[96:99], v[88:91], v[48:63]
    ds_read_b64_tr_b16 v[128:129], v154 offset:0
    ds_read_b64_tr_b16 v[130:131], v154 offset:1024
    v_mfma_f32_32x32x16_bf16 v[64:79], v[96:99], v[92:95], v[64:79]
    ds_read_b64_tr_b16 v[132:133], v155 offset:0
    ds_read_b64_tr_b16 v[134:135], v155 offset:1024
    s_waitcnt lgkmcnt(9)
    v_mfma_f32_32x32x16_bf16 v[16:31], v[116:119], v[100:103], v[16:31]
    ds_read_b128 v[96:99], v145 offset:0
    ds_read_b64_tr_b16 v[80:81], v152 offset:4096
    ds_read_b64_tr_b16 v[82:83], v152 offset:5120
    v_mfma_f32_32x32x16_bf16 v[32:47], v[116:119], v[104:107], v[32:47]
    ds_read_b64_tr_b16 v[84:85], v153 offset:4096
    ds_read_b64_tr_b16 v[86:87], v153 offset:5120
    v_mfma_f32_32x32x16_bf16 v[48:63], v[116:119], v[108:111], v[48:63]
    ds_read_b64_tr_b16 v[88:89], v154 offset:4096
    ds_read_b64_tr_b16 v[90:91], v154 offset:5120
    v_mfma_f32_32x32x16_bf16 v[64:79], v[116:119], v[112:115], v[64:79]
    ds_read_b64_tr_b16 v[92:93], v155 offset:4096
    ds_read_b64_tr_b16 v[94:95], v155 offset:5120
    s_waitcnt lgkmcnt(9)
    v_mfma_f32_32x32x16_bf16 v[16:31], v[136:139], v[120:123], v[16:31]
    ds_read_b128 v[116:119], v146 offset:0
    ds_read_b64_tr_b16 v[100:101], v152 offset:8192
    ds_read_b64_tr_b16 v[102:103], v152 offset:9216
    v_mfma_f32_32x32x16_bf16 v[32:47], v[136:139], v[124:127], v[32:47]
    ds_read_b64_tr_b16 v[104:105], v153 offset:8192
    ds_read_b64_tr_b16 v[106:107], v153 offset:9216
    v_mfma_f32_32x32x16_bf16 v[48:63], v[136:139], v[128:131], v[48:63]
    ds_read_b64_tr_b16 v[108:109], v154 offset:8192
    ds_read_b64_tr_b16 v[110:111], v154 offset:9216
    v_mfma_f32_32x32x16_bf16 v[64:79], v[136:139], v[132:135], v[64:79]
    ds_read_b64_tr_b16 v[112:113], v155 offset:8192
    ds_read_b64_tr_b16 v[114:115], v155 offset:9216
    s_waitcnt lgkmcnt(9)
    v_mfma_f32_32x32x16_bf16 v[16:31], v[96:99], v[80:83], v[16:31]
    ds_read_b128 v[136:139], v147 offset:0
    ds_read_b64_tr_b16 v[120:121], v152 offset:12288
    ds_read_b64_tr_b16 v[122:123], v152 offset:13312
    v_mfma_f32_32x32x16_bf16 v[32:47], v[96:99], v[84:87], v[32:47]
    ds_read_b64_tr_b16 v[124:125], v153 offset:12288
    ds_read_b64_tr_b16 v[126:127], v153 offset:13312
    v_mfma_f32_32x32x16_bf16 v[48:63], v[96:99], v[88:91], v[48:63]
    ds_read_b64_tr_b16 v[128:129], v154 offset:12288
    ds_read_b64_tr_b16 v[130:131], v154 offset:13312
    v_mfma_f32_32x32x16_bf16 v[64:79], v[96:99], v[92:95], v[64:79]
    ds_read_b64_tr_b16 v[132:133], v155 offset:12288
    ds_read_b64_tr_b16 v[134:135], v155 offset:13312
    s_waitcnt lgkmcnt(9)
    v_mfma_f32_32x32x16_bf16 v[16:31], v[116:119], v[100:103], v[16:31]
    s_barrier
    ds_read_b128 v[96:99], v144 offset:32768
    ds_read_b64_tr_b16 v[80:81], v152 offset:32768
    ds_read_b64_tr_b16 v[82:83], v152 offset:33792
    v_mfma_f32_32x32x16_bf16 v[32:47], v[116:119], v[104:107], v[32:47]
    ds_read_b64_tr_b16 v[84:85], v153 offset:32768
    ds_read_b64_tr_b16 v[86:87], v153 offset:33792
    v_mfma_f32_32x32x16_bf16 v[48:63], v[116:119], v[108:111], v[48:63]
    ds_read_b64_tr_b16 v[88:89], v154 offset:32768
    ds_read_b64_tr_b16 v[90:91], v154 offset:33792
    v_mfma_f32_32x32x16_bf16 v[64:79], v[116:119], v[112:115], v[64:79]
    ds_read_b64_tr_b16 v[92:93], v155 offset:32768
    ds_read_b64_tr_b16 v[94:95], v155 offset:33792
    s_waitcnt lgkmcnt(9)
    v_mfma_f32_32x32x16_bf16 v[16:31], v[136:139], v[120:123], v[16:31]
    ds_read_b128 v[116:119], v145 offset:32768
    ds_read_b64_tr_b16 v[100:101], v152 offset:36864
    ds_read_b64_tr_b16 v[102:103], v152 offset:37888
    v_mfma_f32_32x32x16_bf16 v[32:47], v[136:139], v[124:127], v[32:47]
    ds_read_b64_tr_b16 v[104:105], v153 offset:36864
    ds_read_b64_tr_b16 v[106:107], v153 offset:37888
    v_mfma_f32_32x32x16_bf16 v[48:63], v[136:139], v[128:131], v[48:63]
    ds_read_b64_tr_b16 v[108:109], v154 offset:36864
    ds_read_b64_tr_b16 v[110:111], v154 offset:37888
    v_mfma_f32_32x32x16_bf16 v[64:79], v[136:139], v[132:135], v[64:79]
    ds_read_b64_tr_b16 v[112:113], v155 offset:36864
    ds_read_b64_tr_b16 v[114:115], v155 offset:37888
    s_waitcnt lgkmcnt(9)
    v_mfma_f32_32x32x16_bf16 v[16:31], v[96:99], v[80:83], v[16:31]
    ds_read_b128 v[136:139], v146 offset:32768
    ds_read_b64_tr_b16 v[120:121], v152 offset:40960
    ds_read_b64_tr_b16 v[122:123], v152 offset:41984
    v_mfma_f32_32x32x16_bf16 v[32:47], v[96:99], v[84:87], v[32:47]
    ds_read_b64_tr_b16 v[124:125], v153 offset:40960
    ds_read_b64_tr_b16 v[126:127], v153 offset:41984
    v_mfma_f32_32x32x16_bf16 v[48:63], v[96:99], v[88:91], v[48:63]
    ds_read_b64_tr_b16 v[128:129], v154 offset:40960
    ds_read_b64_tr_b16 v[130:131], v154 offset:41984
    v_mfma_f32_32x32x16_bf16 v[64:79], v[96:99], v[92:95], v[64:79]
    ds_read_b64_tr_b16 v[132:133], v155 offset:40960
    ds_read_b64_tr_b16 v[134:135], v155 offset:41984
    s_waitcnt lgkmcnt(9)
    v_mfma_f32_32x32x16_bf16 v[16:31], v[116:119], v[100:103], v[16:31]
    ds_read_b128 v[96:99], v147 offset:32768
    ds_read_b64_tr_b16 v[80:81], v152 offset:45056
    ds_read_b64_tr_b16 v[82:83], v152 offset:46080
    v_mfma_f32_32x32x16_bf16 v[32:47], v[116:119], v[104:107], v[32:47]
    ds_read_b64_tr_b16 v[84:85], v153 offset:45056
    ds_read_b64_tr_b16 v[86:87], v153 offset:46080
    v_mfma_f32_32x32x16_bf16 v[48:63], v[116:119], v[108:111], v[48:63]
    ds_read_b64_tr_b16 v[88:89], v154 offset:45056
    ds_read_b64_tr_b16 v[90:91], v154 offset:46080
    v_mfma_f32_32x32x16_bf16 v[64:79], v[116:119], v[112:115], v[64:79]
    ds_read_b64_tr_b16 v[92:93], v155 offset:45056
    ds_read_b64_tr_b16 v[94:95], v155 offset:46080
    s_waitcnt lgkmcnt(9)
    v_mfma_f32_32x32x16_bf16 v[16:31], v[136:139], v[120:123], v[16:31]
    s_barrier
    ds_read_b128 v[116:119], v140 offset:0
    ds_read_b64_tr_b16 v[100:101], v148 offset:0
    ds_read_b64_tr_b16 v[102:103], v148 offset:1024
    v_mfma_f32_32x32x16_bf16 v[32:47], v[136:139], v[124:127], v[32:47]
    ds_read_b64_tr_b16 v[104:105], v149 offset:0
    ds_read_b64_tr_b16 v[106:107], v149 offset:1024
    v_mfma_f32_32x32x16_bf16 v[48:63], v[136:139], v[128:131], v[48:63]
    ds_read_b64_tr_b16 v[108:109], v150 offset:0
    ds_read_b64_tr_b16 v[110:111], v150 offset:1024
    v_mfma_f32_32x32x16_bf16 v[64:79], v[136:139], v[132:135], v[64:79]
    ds_read_b64_tr_b16 v[112:113], v151 offset:0
    ds_read_b64_tr_b16 v[114:115], v151 offset:1024
    s_waitcnt lgkmcnt(9)
    v_mfma_f32_32x32x16_bf16 v[16:31], v[96:99], v[80:83], v[16:31]
    ds_read_b128 v[136:139], v141 offset:0
    ds_read_b64_tr_b16 v[120:121], v148 offset:4096
    ds_read_b64_tr_b16 v[122:123], v148 offset:5120
    v_mfma_f32_32x32x16_bf16 v[32:47], v[96:99], v[84:87], v[32:47]
    ds_read_b64_tr_b16 v[124:125], v149 offset:4096
    ds_read_b64_tr_b16 v[126:127], v149 offset:5120
    v_mfma_f32_32x32x16_bf16 v[48:63], v[96:99], v[88:91], v[48:63]
    ds_read_b64_tr_b16 v[128:129], v150 offset:4096
    ds_read_b64_tr_b16 v[130:131], v150 offset:5120
    v_mfma_f32_32x32x16_bf16 v[64:79], v[96:99], v[92:95], v[64:79]
    ds_read_b64_tr_b16 v[132:133], v151 offset:4096
    ds_read_b64_tr_b16 v[134:135], v151 offset:5120
    s_waitcnt lgkmcnt(9)
    v_mfma_f32_32x32x16_bf16 v[16:31], v[116:119], v[100:103], v[16:31]
    ds_read_b128 v[96:99], v142 offset:0
    ds_read_b64_tr_b16 v[80:81], v148 offset:8192
    ds_read_b64_tr_b16 v[82:83], v148 offset:9216
    v_mfma_f32_32x32x16_bf16 v[32:47], v[116:119], v[104:107], v[32:47]
    ds_read_b64_tr_b16 v[84:85], v149 offset:8192
    ds_read_b64_tr_b16 v[86:87], v149 offset:9216
    v_mfma_f32_32x32x16_bf16 v[48:63], v[116:119], v[108:111], v[48:63]
    ds_read_b64_tr_b16 v[88:89], v150 offset:8192
    ds_read_b64_tr_b16 v[90:91], v150 offset:9216
    v_mfma_f32_32x32x16_bf16 v[64:79], v[116:119], v[112:115], v[64:79]
    ds_read_b64_tr_b16 v[92:93], v151 offset:8192
    ds_read_b64_tr_b16 v[94:95], v151 offset:9216
    s_waitcnt lgkmcnt(9)
    v_mfma_f32_32x32x16_bf16 v[16:31], v[136:139], v[120:123], v[16:31]
    ds_read_b128 v[116:119], v143 offset:0
    ds_read_b64_tr_b16 v[100:101], v148 offset:12288
    ds_read_b64_tr_b16 v[102:103], v148 offset:13312
    v_mfma_f32_32x32x16_bf16 v[32:47], v[136:139], v[124:127], v[32:47]
    ds_read_b64_tr_b16 v[104:105], v149 offset:12288
    ds_read_b64_tr_b16 v[106:107], v149 offset:13312
    v_mfma_f32_32x32x16_bf16 v[48:63], v[136:139], v[128:131], v[48:63]
    ds_read_b64_tr_b16 v[108:109], v150 offset:12288
    ds_read_b64_tr_b16 v[110:111], v150 offset:13312
    v_mfma_f32_32x32x16_bf16 v[64:79], v[136:139], v[132:135], v[64:79]
    ds_read_b64_tr_b16 v[112:113], v151 offset:12288
    ds_read_b64_tr_b16 v[114:115], v151 offset:13312
    s_waitcnt lgkmcnt(9)
    v_mfma_f32_32x32x16_bf16 v[16:31], v[96:99], v[80:83], v[16:31]
    s_barrier
    ds_read_b128 v[136:139], v140 offset:32768
    ds_read_b64_tr_b16 v[120:121], v148 offset:32768
    ds_read_b64_tr_b16 v[122:123], v148 offset:33792
    v_mfma_f32_32x32x16_bf16 v[32:47], v[96:99], v[84:87], v[32:47]
    ds_read_b64_tr_b16 v[124:125], v149 offset:32768
    ds_read_b64_tr_b16 v[126:127], v149 offset:33792
    v_mfma_f32_32x32x16_bf16 v[48:63], v[96:99], v[88:91], v[48:63]
    ds_read_b64_tr_b16 v[128:129], v150 offset:32768
    ds_read_b64_tr_b16 v[130:131], v150 offset:33792
    v_mfma_f32_32x32x16_bf16 v[64:79], v[96:99], v[92:95], v[64:79]
    ds_read_b64_tr_b16 v[132:133], v151 offset:32768
    ds_read_b64_tr_b16 v[134:135], v151 offset:33792
    s_waitcnt lgkmcnt(9)
    v_mfma_f32_32x32x16_bf16 v[16:31], v[116:119], v[100:103], v[16:31]
    ds_read_b128 v[96:99], v141 offset:32768
    ds_read_b64_tr_b16 v[80:81], v148 offset:36864
    ds_read_b64_tr_b16 v[82:83], v148 offset:37888
    v_mfma_f32_32x32x16_bf16 v[32:47], v[116:119], v[104:107], v[32:47]
    ds_read_b64_tr_b16 v[84:85], v149 offset:36864
    ds_read_b64_tr_b16 v[86:87], v149 offset:37888
    v_mfma_f32_32x32x16_bf16 v[48:63], v[116:119], v[108:111], v[48:63]
    ds_read_b64_tr_b16 v[88:89], v150 offset:36864
    ds_read_b64_tr_b16 v[90:91], v150 offset:37888
    v_mfma_f32_32x32x16_bf16 v[64:79], v[116:119], v[112:115], v[64:79]
    ds_read_b64_tr_b16 v[92:93], v151 offset:36864
    ds_read_b64_tr_b16 v[94:95], v151 offset:37888
    s_waitcnt lgkmcnt(9)
    v_mfma_f32_32x32x16_bf16 v[16:31], v[136:139], v[120:123], v[16:31]
    ds_read_b128 v[116:119], v142 offset:32768
    ds_read_b64_tr_b16 v[100:101], v148 offset:40960
    ds_read_b64_tr_b16 v[102:103], v148 offset:41984
    v_mfma_f32_32x32x16_bf16 v[32:47], v[136:139], v[124:127], v[32:47]
    ds_read_b64_tr_b16 v[104:105], v149 offset:40960
    ds_read_b64_tr_b16 v[106:107], v149 offset:41984
    v_mfma_f32_32x32x16_bf16 v[48:63], v[136:139], v[128:131], v[48:63]
    ds_read_b64_tr_b16 v[108:109], v150 offset:40960
    ds_read_b64_tr_b16 v[110:111], v150 offset:41984
    v_mfma_f32_32x32x16_bf16 v[64:79], v[136:139], v[132:135], v[64:79]
    ds_read_b64_tr_b16 v[112:113], v151 offset:40960
    ds_read_b64_tr_b16 v[114:115], v151 offset:41984
    s_waitcnt lgkmcnt(9)
    v_mfma_f32_32x32x16_bf16 v[16:31], v[96:99], v[80:83], v[16:31]
    ds_read_b128 v[136:139], v143 offset:32768
    ds_read_b64_tr_b16 v[120:121], v148 offset:45056
    ds_read_b64_tr_b16 v[122:123], v148 offset:46080
    v_mfma_f32_32x32x16_bf16 v[32:47], v[96:99], v[84:87], v[32:47]
    ds_read_b64_tr_b16 v[124:125], v149 offset:45056
    ds_read_b64_tr_b16 v[126:127], v149 offset:46080
    v_mfma_f32_32x32x16_bf16 v[48:63], v[96:99], v[88:91], v[48:63]
    ds_read_b64_tr_b16 v[128:129], v150 offset:45056
    ds_read_b64_tr_b16 v[130:131], v150 offset:46080
    v_mfma_f32_32x32x16_bf16 v[64:79], v[96:99], v[92:95], v[64:79]
    ds_read_b64_tr_b16 v[132:133], v151 offset:45056
    ds_read_b64_tr_b16 v[134:135], v151 offset:46080
    s_waitcnt lgkmcnt(9)
    v_mfma_f32_32x32x16_bf16 v[16:31], v[116:119], v[100:103], v[16:31]
    s_barrier
    ds_read_b128 v[96:99], v144 offset:0
    ds_read_b64_tr_b16 v[80:81], v152 offset:0
    ds_read_b64_tr_b16 v[82:83], v152 offset:1024
    v_mfma_f32_32x32x16_bf16 v[32:47], v[116:119], v[104:107], v[32:47]
    ds_read_b64_tr_b16 v[84:85], v153 offset:0
    ds_read_b64_tr_b16 v[86:87], v153 offset:1024
    v_mfma_f32_32x32x16_bf16 v[48:63], v[116:119], v[108:111], v[48:63]
    ds_read_b64_tr_b16 v[88:89], v154 offset:0
    ds_read_b64_tr_b16 v[90:91], v154 offset:1024
    v_mfma_f32_32x32x16_bf16 v[64:79], v[116:119], v[112:115], v[64:79]
    ds_read_b64_tr_b16 v[92:93], v155 offset:0
    ds_read_b64_tr_b16 v[94:95], v155 offset:1024
    s_waitcnt lgkmcnt(9)
    v_mfma_f32_32x32x16_bf16 v[16:31], v[136:139], v[120:123], v[16:31]
    ds_read_b128 v[116:119], v145 offset:0
    ds_read_b64_tr_b16 v[100:101], v152 offset:4096
    ds_read_b64_tr_b16 v[102:103], v152 offset:5120
    v_mfma_f32_32x32x16_bf16 v[32:47], v[136:139], v[124:127], v[32:47]
    ds_read_b64_tr_b16 v[104:105], v153 offset:4096
    ds_read_b64_tr_b16 v[106:107], v153 offset:5120
    v_mfma_f32_32x32x16_bf16 v[48:63], v[136:139], v[128:131], v[48:63]
    ds_read_b64_tr_b16 v[108:109], v154 offset:4096
    ds_read_b64_tr_b16 v[110:111], v154 offset:5120
    v_mfma_f32_32x32x16_bf16 v[64:79], v[136:139], v[132:135], v[64:79]
    ds_read_b64_tr_b16 v[112:113], v155 offset:4096
    ds_read_b64_tr_b16 v[114:115], v155 offset:5120
    s_waitcnt lgkmcnt(9)
    v_mfma_f32_32x32x16_bf16 v[16:31], v[96:99], v[80:83], v[16:31]
    ds_read_b128 v[136:139], v146 offset:0
    ds_read_b64_tr_b16 v[120:121], v152 offset:8192
    ds_read_b64_tr_b16 v[122:123], v152 offset:9216
    v_mfma_f32_32x32x16_bf16 v[32:47], v[96:99], v[84:87], v[32:47]
    ds_read_b64_tr_b16 v[124:125], v153 offset:8192
    ds_read_b64_tr_b16 v[126:127], v153 offset:9216
    v_mfma_f32_32x32x16_bf16 v[48:63], v[96:99], v[88:91], v[48:63]
    ds_read_b64_tr_b16 v[128:129], v154 offset:8192
    ds_read_b64_tr_b16 v[130:131], v154 offset:9216
    v_mfma_f32_32x32x16_bf16 v[64:79], v[96:99], v[92:95], v[64:79]
    ds_read_b64_tr_b16 v[132:133], v155 offset:8192
    ds_read_b64_tr_b16 v[134:135], v155 offset:9216
    s_waitcnt lgkmcnt(9)
    v_mfma_f32_32x32x16_bf16 v[16:31], v[116:119], v[100:103], v[16:31]
    ds_read_b128 v[96:99], v147 offset:0
    ds_read_b64_tr_b16 v[80:81], v152 offset:12288
    ds_read_b64_tr_b16 v[82:83], v152 offset:13312
    v_mfma_f32_32x32x16_bf16 v[32:47], v[116:119], v[104:107], v[32:47]
    ds_read_b64_tr_b16 v[84:85], v153 offset:12288
    ds_read_b64_tr_b16 v[86:87], v153 offset:13312
    v_mfma_f32_32x32x16_bf16 v[48:63], v[116:119], v[108:111], v[48:63]
    ds_read_b64_tr_b16 v[88:89], v154 offset:12288
    ds_read_b64_tr_b16 v[90:91], v154 offset:13312
    v_mfma_f32_32x32x16_bf16 v[64:79], v[116:119], v[112:115], v[64:79]
    ds_read_b64_tr_b16 v[92:93], v155 offset:12288
    ds_read_b64_tr_b16 v[94:95], v155 offset:13312
    s_waitcnt lgkmcnt(9)
    v_mfma_f32_32x32x16_bf16 v[16:31], v[136:139], v[120:123], v[16:31]
    s_barrier
    ds_read_b128 v[116:119], v144 offset:32768
    ds_read_b64_tr_b16 v[100:101], v152 offset:32768
    ds_read_b64_tr_b16 v[102:103], v152 offset:33792
    v_mfma_f32_32x32x16_bf16 v[32:47], v[136:139], v[124:127], v[32:47]
    ds_read_b64_tr_b16 v[104:105], v153 offset:32768
    ds_read_b64_tr_b16 v[106:107], v153 offset:33792
    v_mfma_f32_32x32x16_bf16 v[48:63], v[136:139], v[128:131], v[48:63]
    ds_read_b64_tr_b16 v[108:109], v154 offset:32768
    ds_read_b64_tr_b16 v[110:111], v154 offset:33792
    v_mfma_f32_32x32x16_bf16 v[64:79], v[136:139], v[132:135], v[64:79]
    ds_read_b64_tr_b16 v[112:113], v155 offset:32768
    ds_read_b64_tr_b16 v[114:115], v155 offset:33792
    s_waitcnt lgkmcnt(9)
    v_mfma_f32_32x32x16_bf16 v[16:31], v[96:99], v[80:83], v[16:31]
    ds_read_b128 v[136:139], v145 offset:32768
    ds_read_b64_tr_b16 v[120:121], v152 offset:36864
    ds_read_b64_tr_b16 v[122:123], v152 offset:37888
    v_mfma_f32_32x32x16_bf16 v[32:47], v[96:99], v[84:87], v[32:47]
    ds_read_b64_tr_b16 v[124:125], v153 offset:36864
    ds_read_b64_tr_b16 v[126:127], v153 offset:37888
    v_mfma_f32_32x32x16_bf16 v[48:63], v[96:99], v[88:91], v[48:63]
    ds_read_b64_tr_b16 v[128:129], v154 offset:36864
    ds_read_b64_tr_b16 v[130:131], v154 offset:37888
    v_mfma_f32_32x32x16_bf16 v[64:79], v[96:99], v[92:95], v[64:79]
    ds_read_b64_tr_b16 v[132:133], v155 offset:36864
    ds_read_b64_tr_b16 v[134:135], v155 offset:37888
    s_waitcnt lgkmcnt(9)
    v_mfma_f32_32x32x16_bf16 v[16:31], v[116:119], v[100:103], v[16:31]
    ds_read_b128 v[96:99], v146 offset:32768
    ds_read_b64_tr_b16 v[80:81], v152 offset:40960
    ds_read_b64_tr_b16 v[82:83], v152 offset:41984
    v_mfma_f32_32x32x16_bf16 v[32:47], v[116:119], v[104:107], v[32:47]
    ds_read_b64_tr_b16 v[84:85], v153 offset:40960
    ds_read_b64_tr_b16 v[86:87], v153 offset:41984
    v_mfma_f32_32x32x16_bf16 v[48:63], v[116:119], v[108:111], v[48:63]
    ds_read_b64_tr_b16 v[88:89], v154 offset:40960
    ds_read_b64_tr_b16 v[90:91], v154 offset:41984
    v_mfma_f32_32x32x16_bf16 v[64:79], v[116:119], v[112:115], v[64:79]
    ds_read_b64_tr_b16 v[92:93], v155 offset:40960
    ds_read_b64_tr_b16 v[94:95], v155 offset:41984
    s_waitcnt lgkmcnt(9)
    v_mfma_f32_32x32x16_bf16 v[16:31], v[136:139], v[120:123], v[16:31]
    ds_read_b128 v[116:119], v147 offset:32768
    ds_read_b64_tr_b16 v[100:101], v152 offset:45056
    ds_read_b64_tr_b16 v[102:103], v152 offset:46080
    v_mfma_f32_32x32x16_bf16 v[32:47], v[136:139], v[124:127], v[32:47]
    ds_read_b64_tr_b16 v[104:105], v153 offset:45056
    ds_read_b64_tr_b16 v[106:107], v153 offset:46080
    v_mfma_f32_32x32x16_bf16 v[48:63], v[136:139], v[128:131], v[48:63]
    ds_read_b64_tr_b16 v[108:109], v154 offset:45056
    ds_read_b64_tr_b16 v[110:111], v154 offset:46080
    v_mfma_f32_32x32x16_bf16 v[64:79], v[136:139], v[132:135], v[64:79]
    ds_read_b64_tr_b16 v[112:113], v155 offset:45056
    ds_read_b64_tr_b16 v[114:115], v155 offset:46080
    s_waitcnt lgkmcnt(9)
    v_mfma_f32_32x32x16_bf16 v[16:31], v[96:99], v[80:83], v[16:31]
    s_barrier
    s_setprio 2
    ds_read_b128 v[136:139], v140 offset:0
    ds_read_b64_tr_b16 v[120:121], v148 offset:0
    ds_read_b64_tr_b16 v[122:123], v148 offset:1024
    v_mfma_f32_32x32x16_bf16 v[32:47], v[96:99], v[84:87], v[32:47]
    ds_read_b64_tr_b16 v[124:125], v149 offset:0
    ds_read_b64_tr_b16 v[126:127], v149 offset:1024
    v_mfma_f32_32x32x16_bf16 v[48:63], v[96:99], v[88:91], v[48:63]
    ds_read_b64_tr_b16 v[128:129], v150 offset:0
    ds_read_b64_tr_b16 v[130:131], v150 offset:1024
    v_mfma_f32_32x32x16_bf16 v[64:79], v[96:99], v[92:95], v[64:79]
    ds_read_b64_tr_b16 v[132:133], v151 offset:0
    ds_read_b64_tr_b16 v[134:135], v151 offset:1024
    s_waitcnt lgkmcnt(9)
    v_mfma_f32_32x32x16_bf16 v[16:31], v[116:119], v[100:103], v[16:31]
    ds_read_b128 v[96:99], v141 offset:0
    ds_read_b64_tr_b16 v[80:81], v148 offset:4096
    ds_read_b64_tr_b16 v[82:83], v148 offset:5120
    v_mfma_f32_32x32x16_bf16 v[32:47], v[116:119], v[104:107], v[32:47]
    ds_read_b64_tr_b16 v[84:85], v149 offset:4096
    ds_read_b64_tr_b16 v[86:87], v149 offset:5120
    v_mfma_f32_32x32x16_bf16 v[48:63], v[116:119], v[108:111], v[48:63]
    ds_read_b64_tr_b16 v[88:89], v150 offset:4096
    ds_read_b64_tr_b16 v[90:91], v150 offset:5120
    v_mfma_f32_32x32x16_bf16 v[64:79], v[116:119], v[112:115], v[64:79]
    ds_read_b64_tr_b16 v[92:93], v151 offset:4096
    ds_read_b64_tr_b16 v[94:95], v151 offset:5120
    s_waitcnt lgkmcnt(9)
    v_mfma_f32_32x32x16_bf16 v[16:31], v[136:139], v[120:123], v[16:31]
    ds_read_b128 v[116:119], v142 offset:0
    ds_read_b64_tr_b16 v[100:101], v148 offset:8192
    ds_read_b64_tr_b16 v[102:103], v148 offset:9216
    v_mfma_f32_32x32x16_bf16 v[32:47], v[136:139], v[124:127], v[32:47]
    ds_read_b64_tr_b16 v[104:105], v149 offset:8192
    ds_read_b64_tr_b16 v[106:107], v149 offset:9216
    v_mfma_f32_32x32x16_bf16 v[48:63], v[136:139], v[128:131], v[48:63]
    ds_read_b64_tr_b16 v[108:109], v150 offset:8192
    ds_read_b64_tr_b16 v[110:111], v150 offset:9216
    v_mfma_f32_32x32x16_bf16 v[64:79], v[136:139], v[132:135], v[64:79]
    ds_read_b64_tr_b16 v[112:113], v151 offset:8192
    ds_read_b64_tr_b16 v[114:115], v151 offset:9216
    s_waitcnt lgkmcnt(9)
    v_mfma_f32_32x32x16_bf16 v[16:31], v[96:99], v[80:83], v[16:31]
    ds_read_b128 v[136:139], v143 offset:0
    ds_read_b64_tr_b16 v[120:121], v148 offset:12288
    ds_read_b64_tr_b16 v[122:123], v148 offset:13312
    ds_read_b64_tr_b16 v[124:125], v149 offset:12288
    ds_read_b64_tr_b16 v[126:127], v149 offset:13312
    v_mfma_f32_32x32x16_bf16 v[32:47], v[96:99], v[84:87], v[32:47]
    ds_read_b64_tr_b16 v[128:129], v150 offset:12288
    ds_read_b64_tr_b16 v[130:131], v150 offset:13312
    ds_read_b64_tr_b16 v[132:133], v151 offset:12288
    ds_read_b64_tr_b16 v[134:135], v151 offset:13312
    s_waitcnt lgkmcnt(9)
    v_mfma_f32_32x32x16_bf16 v[16:31], v[116:119], v[100:103], v[16:31]
    v_mfma_f32_32x32x16_bf16 v[32:47], v[116:119], v[104:107], v[32:47]
    v_mfma_f32_32x32x16_bf16 v[48:63], v[96:99], v[88:91], v[48:63]
    s_waitcnt lgkmcnt(0)
    v_mfma_f32_32x32x16_bf16 v[16:31], v[136:139], v[120:123], v[16:31]
    s_mov_b64 exec, 1
    ds_add_u32 v3, v1 offset:4
    s_mov_b64 exec, -1
    v_mfma_f32_32x32x16_bf16 v[32:47], v[136:139], v[124:127], v[32:47]
    v_mfma_f32_32x32x16_bf16 v[48:63], v[116:119], v[108:111], v[48:63]
    s_nop 6
    v_mfma_f32_32x32x16_bf16 v[48:63], v[136:139], v[128:131], v[48:63]
    v_cvt_pk_bf16_f32 v16, v16, v17
    v_cvt_pk_bf16_f32 v17, v18, v19
    v_cvt_pk_bf16_f32 v18, v20, v21
    v_cvt_pk_bf16_f32 v19, v22, v23
    v_cvt_pk_bf16_f32 v20, v24, v25
    v_cvt_pk_bf16_f32 v21, v26, v27
    v_cvt_pk_bf16_f32 v22, v28, v29
    v_cvt_pk_bf16_f32 v23, v30, v31
    v_mfma_f32_32x32x16_bf16 v[64:79], v[96:99], v[92:95], v[64:79]
    buffer_store_dwordx4 v[16:19], v157, s[16:19], s36 offen offset:0 sc1
    buffer_store_dwordx4 v[20:23], v157, s[16:19], s37 offen offset:0 sc1
    v_mfma_f32_32x32x16_bf16 v[64:79], v[116:119], v[112:115], v[64:79]
    v_cvt_pk_bf16_f32 v32, v32, v33
    v_cvt_pk_bf16_f32 v33, v34, v35
    v_cvt_pk_bf16_f32 v34, v36, v37
    v_cvt_pk_bf16_f32 v35, v38, v39
    v_cvt_pk_bf16_f32 v36, v40, v41
    v_cvt_pk_bf16_f32 v37, v42, v43
    v_cvt_pk_bf16_f32 v38, v44, v45
    v_cvt_pk_bf16_f32 v39, v46, v47
    v_mfma_f32_32x32x16_bf16 v[64:79], v[136:139], v[132:135], v[64:79]
    buffer_store_dwordx4 v[32:35], v157, s[16:19], s36 offen offset:512 sc1
    buffer_store_dwordx4 v[36:39], v157, s[16:19], s37 offen offset:512 sc1
    s_cmp_eq_u32 s42, 13
    s_cbranch_scc1 G_PUB
    v_cvt_pk_bf16_f32 v48, v48, v49
    v_cvt_pk_bf16_f32 v49, v50, v51
    v_cvt_pk_bf16_f32 v50, v52, v53
    v_cvt_pk_bf16_f32 v51, v54, v55
    v_cvt_pk_bf16_f32 v52, v56, v57
    v_cvt_pk_bf16_f32 v53, v58, v59
    v_cvt_pk_bf16_f32 v54, v60, v61
    v_cvt_pk_bf16_f32 v55, v62, v63
    buffer_store_dwordx4 v[48:51], v157, s[16:19], s36 offen offset:1024 sc1
    buffer_store_dwordx4 v[52:55], v157, s[16:19], s37 offen offset:1024 sc1
    v_cvt_pk_bf16_f32 v64, v64, v65
    v_cvt_pk_bf16_f32 v65, v66, v67
    v_cvt_pk_bf16_f32 v66, v68, v69
    v_cvt_pk_bf16_f32 v67, v70, v71
    v_cvt_pk_bf16_f32 v68, v72, v73
    v_cvt_pk_bf16_f32 v69, v74, v75
    v_cvt_pk_bf16_f32 v70, v76, v77
    v_cvt_pk_bf16_f32 v71, v78, v79
    buffer_store_dwordx4 v[64:67], v157, s[16:19], s36 offen offset:1536 sc1
    buffer_store_dwordx4 v[68:71], v157, s[16:19], s37 offen offset:1536 sc1
G_PUB:
    s_nop 7
    v_mov_b32 v102, v10
    v_mov_b32 v103, v10
    v_mov_b32 v104, v10
    v_mov_b32 v105, v10
    v_mov_b32 v106, v10
    v_mov_b32 v107, v10
    v_mov_b32 v108, v10
    v_mov_b32 v109, v10
    v_mov_b32 v116, v10
    v_mov_b32 v117, v10
    v_mov_b32 v118, v10
    v_mov_b32 v119, v10
    v_mov_b32 v120, v10
    v_mov_b32 v121, v10
    v_mov_b32 v122, v10
    v_mov_b32 v123, v10
    v_mov_b32 v130, v10
    v_mov_b32 v131, v10
    v_mov_b32 v132, v10
    v_mov_b32 v133, v10
    v_mov_b32 v134, v10
    v_mov_b32 v135, v10
    v_mov_b32 v136, v10
    v_mov_b32 v137, v10
    v_mov_b32 v144, v10
    v_mov_b32 v145, v10
    v_mov_b32 v146, v10
    v_mov_b32 v147, v10
    v_mov_b32 v148, v10
    v_mov_b32 v149, v10
    v_mov_b32 v150, v10
    v_mov_b32 v151, v10
    v_mov_b32 v64, 0
    v_mov_b32 v80, 0
    v_mov_b32 v65, 0
    v_mov_b32 v81, 0
    v_mov_b32 v66, 0
    v_mov_b32 v82, 0
    v_mov_b32 v67, 0
    v_mov_b32 v83, 0
    v_mov_b32 v68, 0
    v_mov_b32 v84, 0
    v_mov_b32 v69, 0
    v_mov_b32 v85, 0
    v_mov_b32 v70, 0
    v_mov_b32 v86, 0
    v_mov_b32 v71, 0
    v_mov_b32 v87, 0
    v_mov_b32 v72, 0
    v_mov_b32 v88, 0
    v_mov_b32 v73, 0
    v_mov_b32 v89, 0
    v_mov_b32 v74, 0
    v_mov_b32 v90, 0
    v_mov_b32 v75, 0
    v_mov_b32 v91, 0
    v_mov_b32 v76, 0
    v_mov_b32 v92, 0
    v_mov_b32 v77, 0
    v_mov_b32 v93, 0
    v_mov_b32 v78, 0
    v_mov_b32 v94, 0
    v_mov_b32 v79, 0
    v_mov_b32 v95, 0
    v_mov_b32 v56, 0
    v_mov_b32 v57, 0
    v_mov_b32 v58, 0
    v_mov_b32 v59, 0
    v_mov_b32 v60, 0
    v_mov_b32 v61, 0
    v_mov_b32 v62, 0
    v_mov_b32 v63, 0
    s_mov_b32 s97, 4194304
LW_12:
    ds_read_b32 v2, v3 offset:96
    s_waitcnt lgkmcnt(0)
    v_readfirstlane_b32 s96, v2
    s_cmp_ge_u32 s96, 1
    s_cbranch_scc1 LWOK_13
    s_sub_u32 s97, s97, 1
    s_cbranch_scc0 LW_12
LWOK_13:
    s_mov_b32 s74, s96
    s_setprio 0
    s_waitcnt vmcnt(0)
    s_mov_b64 exec, 1
    ds_add_rtn_u32 v2, v3, v1 offset:116
    s_mov_b64 exec, -1
    s_waitcnt lgkmcnt(0)
    v_readfirstlane_b32 s96, v2
    s_cmp_lg_u32 s96, 3
    s_cbranch_scc1 PB_14
    v_mov_b32 v14, 0
    v_mov_b32 v15, s74
    s_mov_b64 exec, 1
    buffer_store_dword v15, v14, s[16:19], s38 offen sc1
    s_mov_b64 exec, -1
PB_14:
    s_branch A_WAITGO
F_ATTN:
    s_and_b32 s4, s2, 7
    s_lshl_b32 s4, s4, 2
    s_bfe_u32 s5, s2, 0x20003
    s_add_u32 s4, s4, s5
    s_lshr_b32 s5, s2, 5
    s_lshr_b32 s6, s3, 2
    s_and_b32 s7, s3, 3
    s_lshl_b32 s7, s7, 1
    s_lshl_b32 s5, s5, 3
    s_add_u32 s7, s5, s7
    s_mov_b32 s30, s7
    s_add_u32 s31, s30, 1
    s_mul_i32 s12, s4, 18
    s_lshr_b32 s13, s12, 3
    s_lshl_b32 s8, s13, 9
    s_add_u32 s9, s8, 36864
    v_lshl_add_u32 v7, v0, 4, s9
    v_lshlrev_b32 v8, 4, v4
    v_lshl_add_u32 v8, v5, 3, v8
    s_add_u32 s9, s9, 1024
    v_add_u32 v8, s9, v8
    v_subrev_u32 v163, 36864, v7
    v_subrev_u32 v164, 36864, v8
    s_mul_i32 s24, s30, 110592
    s_mul_i32 s25, s31, 110592
    v_mul_u32_u24 v9, 9216, v5
    v_lshl_add_u32 v9, v4, 4, v9
    s_lshl_b32 s9, s12, 4
    s_add_u32 s9, s9, 73728
    v_add_u32 v9, s9, v9
    v_add_u32 v162, 18432, v9
    s_mov_b32 s22, 0x3ffff
    s_mov_b32 s23, 0x3ffff
    s_mul_i32 s14, s6, 3538944
    s_add_u32 s29, s14, 3538944
    s_mov_b32 s28, s14
    v_mov_b32 v6, 0xdddddddd
    s_mov_b32 s15, 0
    v_mov_b32 v10, 1065369472
    v_and_b32 v11, 27, v4
    v_cmp_eq_u32 vcc, 18, v11
    s_and_b32 s9, s4, 3
    v_lshlrev_b32 v12, 2, v5
    v_cndmask_b32 v10, 0, v10, vcc
    v_subrev_u32 v12, s9, v12
    v_cmp_le_i32 s[60:61], 0, v12
    v_cmp_le_i32 s[62:63], -1, v12
    v_cmp_le_i32 s[64:65], -2, v12
    v_cmp_le_i32 s[66:67], -3, v12
    v_lshlrev_b32 v12, 1, v5
    v_subrev_u32 v12, s9, v12
    v_cmp_ge_i32 s[68:69], 0, v12
    v_cmp_ge_i32 s[70:71], -1, v12
    v_bfe_u32 v11, v0, 3, 2
    v_and_b32 v12, 1, v11
    s_add_u32 s9, s13, 72
    v_lshl_add_u32 v13, v12, 1, s9
    v_lshrrev_b32 v13, 4, v13
    s_add_u32 s9, s12, 1152
    v_mad_u32_u24 v14, v12, 17, s9
    v_lshrrev_b32 v14, 7, v14
    v_cmp_gt_u32 vcc, 2, v11
    v_lshl_add_u32 v15, v12, 1, s13
    v_lshrrev_b32 v15, 4, v15
    v_cndmask_b32 v13, v14, v13, vcc
    v_and_b32 v11, 7, v0
    s_lshl_b32 s9, s6, 3
    v_add_u32 v14, s9, v11
    v_lshl_add_u32 v13, v13, 4, v14
    v_and_b32 v11, 1, v0
    s_lshr_b32 s9, s5, 2
    v_add_u32 v11, s9, v11
    v_cmp_eq_u32 vcc, 0, v5
    v_lshl_add_u32 v15, v15, 4, v11
    s_lshl_b32 s26, s6, 2
    v_cndmask_b32 v11, v15, v13, vcc
    v_lshlrev_b32 v11, 7, v11
    v_add_u32 v160, 14856192, v11
    v_add_u32 v13, s26, v3
    v_mov_b32 v102, v10
    v_mov_b32 v103, v10
    v_mov_b32 v104, v10
    v_mov_b32 v105, v10
    v_mov_b32 v106, v10
    v_mov_b32 v107, v10
    v_mov_b32 v108, v10
    v_mov_b32 v109, v10
    v_mov_b32 v116, v10
    v_mov_b32 v117, v10
    v_mov_b32 v118, v10
    v_mov_b32 v119, v10
    v_mov_b32 v120, v10
    v_mov_b32 v121, v10
    v_mov_b32 v122, v10
    v_mov_b32 v123, v10
    v_mov_b32 v130, v10
    v_mov_b32 v131, v10
    v_mov_b32 v132, v10
    v_mov_b32 v133, v10
    v_mov_b32 v134, v10
    v_mov_b32 v135, v10
    v_mov_b32 v136, v10
    v_mov_b32 v137, v10
    v_mov_b32 v144, v10
    v_mov_b32 v145, v10
    v_mov_b32 v146, v10
    v_mov_b32 v147, v10
    v_mov_b32 v148, v10
    v_mov_b32 v149, v10
    v_mov_b32 v150, v10
    v_mov_b32 v151, v10
    v_mov_b32 v64, 0
    v_mov_b32 v80, 0
    v_mov_b32 v65, 0
    v_mov_b32 v81, 0
    v_mov_b32 v66, 0
    v_mov_b32 v82, 0
    v_mov_b32 v67, 0
    v_mov_b32 v83, 0
    v_mov_b32 v68, 0
    v_mov_b32 v84, 0
    v_mov_b32 v69, 0
    v_mov_b32 v85, 0
    v_mov_b32 v70, 0
    v_mov_b32 v86, 0
    v_mov_b32 v71, 0
    v_mov_b32 v87, 0
    v_mov_b32 v72, 0
    v_mov_b32 v88, 0
    v_mov_b32 v73, 0
    v_mov_b32 v89, 0
    v_mov_b32 v74, 0
    v_mov_b32 v90, 0
    v_mov_b32 v75, 0
    v_mov_b32 v91, 0
    v_mov_b32 v76, 0
    v_mov_b32 v92, 0
    v_mov_b32 v77, 0
    v_mov_b32 v93, 0
    v_mov_b32 v78, 0
    v_mov_b32 v94, 0
    v_mov_b32 v79, 0
    v_mov_b32 v95, 0
    v_mov_b32 v56, 0
    v_mov_b32 v57, 0
    v_mov_b32 v58, 0
    v_mov_b32 v59, 0
    v_mov_b32 v60, 0
    v_mov_b32 v61, 0
    v_mov_b32 v62, 0
    v_mov_b32 v63, 0
    s_mov_b32 s97, 4194304
LW_15:
    ds_read_b32 v2, v3 offset:96
    s_waitcnt lgkmcnt(0)
    v_readfirstlane_b32 s96, v2
    s_cmp_ge_u32 s96, 1
    s_cbranch_scc1 LWOK_16
    s_sub_u32 s97, s97, 1
    s_cbranch_scc0 LW_15
LWOK_16:
    s_mov_b32 s74, s96
A_READY:
    s_cmp_ge_u32 s3, 2
    s_cbranch_scc1 A_WAITGO
    s_lshl_b32 s26, s3, 10
    v_mov_b32 v12, s26
    s_lshl_b32 s26, s3, 2
    v_cndmask_b32 v12, 0, v12, vcc
    v_add_u32 v14, v160, v12
    v_add_u32 v15, s26, v3
    s_setprio 3
    s_mov_b32 s97, 4194304
LW_17:
    ds_read_b32 v2, v3 offset:116
    s_waitcnt lgkmcnt(0)
    v_readfirstlane_b32 s96, v2
    s_cmp_ge_u32 s96, 1
    s_cbranch_scc1 LWOK_18
    s_sleep 2
    s_sub_u32 s97, s97, 1
    s_cbranch_scc0 LW_17
LWOK_18:
    s_mov_b32 s97, 262144
    s_lshr_b32 s27, s5, 3
    s_lshl_b32 s8, 0x01010101, s27
    s_mov_b32 s9, 0x303
    s_mov_b64 exec, s[8:9]
A_POLL:
    buffer_load_dword v12, v14, s[16:19], 0 offen sc1
    s_waitcnt vmcnt(0)
    v_cmp_ne_u32 vcc, s74, v12
    s_cmp_eq_u64 vcc, 0
    s_cbranch_scc1 A_POK
    s_sleep 1
    s_sub_u32 s97, s97, 1
    s_cbranch_scc0 A_POLL
A_POK:
    s_mov_b64 exec, -1
    s_add_u32 s96, s27, 24
    v_mov_b32 v12, s96
    ds_write_b32 v15, v12 offset:16
A_WAITGO:
    s_setprio 3
    s_mov_b32 s97, 4194304
A_WG:
    ds_read_b32 v2, v13 offset:16
    s_waitcnt lgkmcnt(0)
    v_readfirstlane_b32 s96, v2
    s_cmp_lg_u32 s96, 0
    s_cbranch_scc1 A_GO
    s_sleep 1
    s_sub_u32 s97, s97, 1
    s_cbranch_scc0 A_WG
A_GO:
    buffer_load_dwordx4 v[16:19], v163, s[16:19], s24 offen sc1
    buffer_load_dwordx2 v[20:21], v164, s[16:19], s24 offen sc1
    s_and_b32 s26, s96, 7
    s_mul_i32 s26, s26, 442368
    s_add_u32 s20, s14, s26
    s_lshr_b32 s27, s96, 4
    buffer_load_dwordx4 v[96:99], v7, s[16:19], s20 offen
    buffer_load_dwordx2 v[100:101], v8, s[16:19], s20 offen
    s_mov_b64 exec, s[22:23]
    buffer_load_dwordx4 v[102:105], v9, s[16:19], s20 offen
    buffer_load_dwordx4 v[106:109], v162, s[16:19], s20 offen
    s_mov_b64 exec, -1
    s_add_u32 s20, s20, 110592
    buffer_load_dwordx4 v[24:27], v163, s[16:19], s25 offen sc1
    buffer_load_dwordx2 v[28:29], v164, s[16:19], s25 offen sc1
    buffer_load_dwordx4 v[110:113], v7, s[16:19], s20 offen
    buffer_load_dwordx2 v[114:115], v8, s[16:19], s20 offen
    s_mov_b64 exec, s[22:23]
    buffer_load_dwordx4 v[116:119], v9, s[16:19], s20 offen
    buffer_load_dwordx4 v[120:123], v162, s[16:19], s20 offen
    s_mov_b64 exec, -1
    s_add_u32 s20, s20, 110592
    buffer_load_dwordx4 v[124:127], v7, s[16:19], s20 offen
    buffer_load_dwordx2 v[128:129], v8, s[16:19], s20 offen
    s_mov_b64 exec, s[22:23]
    buffer_load_dwordx4 v[130:133], v9, s[16:19], s20 offen
    buffer_load_dwordx4 v[134:137], v162, s[16:19], s20 offen
    s_mov_b64 exec, -1
    s_add_u32 s20, s20, 110592
    s_mov_b32 s21, 8
    s_waitcnt vmcnt(8)
    s_setprio 2
    buffer_load_dword v161, v160, s[16:19], 0 offen sc1
    v_cndmask_b32 v16, 0, v16, s[60:61]
    v_cndmask_b32 v17, 0, v17, s[62:63]
    v_cndmask_b32 v18, 0, v18, s[64:65]
    v_cndmask_b32 v19, 0, v19, s[66:67]
    v_cndmask_b32 v20, 0, v20, s[68:69]
    v_cndmask_b32 v21, 0, v21, s[70:71]
    v_cndmask_b32 v24, 0, v24, s[60:61]
    v_cndmask_b32 v25, 0, v25, s[62:63]
    v_cndmask_b32 v26, 0, v26, s[64:65]
    v_cndmask_b32 v27, 0, v27, s[66:67]
    v_cndmask_b32 v28, 0, v28, s[68:69]
    v_cndmask_b32 v29, 0, v29, s[70:71]
    v_mfma_f32_32x32x8_bf16 v[32:47], v[100:101], v[20:21], 0
    v_mfma_f32_32x32x16_bf16 v[32:47], v[96:99], v[16:19], v[32:47]
    s_nop 15
.p2align 3
A_LOOP:
    v_exp_f32 v32, v32
    v_exp_f32 v33, v33
    v_smfmac_f32_32x32x32_bf16 v[80:95], v[148:151], v[56:63], v6
    v_exp_f32 v34, v34
    v_exp_f32 v35, v35
    v_exp_f32 v36, v36
    v_mfma_f32_32x32x8_bf16 v[48:63], v[100:101], v[28:29], 0
    v_exp_f32 v37, v37
    v_exp_f32 v38, v38
    v_exp_f32 v39, v39
    v_exp_f32 v40, v40
    v_mfma_f32_32x32x16_bf16 v[48:63], v[96:99], v[24:27], v[48:63]
    s_bitcmp1_b32 18, s21
    s_cbranch_scc1 A_PRIO
A_PRIOD:
    buffer_load_dwordx4 v[138:141], v7, s[16:19], s20 offen
    v_exp_f32 v41, v41
    v_exp_f32 v42, v42
    v_exp_f32 v43, v43
    v_smfmac_f32_32x32x32_bf16 v[64:79], v[102:105], v[32:39], v6
    buffer_load_dwordx2 v[142:143], v8, s[16:19], s20 offen
    v_exp_f32 v44, v44
    v_exp_f32 v45, v45
    v_exp_f32 v46, v46
    v_exp_f32 v47, v47
    v_exp_f32 v48, v48
    v_exp_f32 v49, v49
    v_smfmac_f32_32x32x32_bf16 v[64:79], v[106:109], v[40:47], v6
    s_waitcnt vmcnt(6)
    v_exp_f32 v50, v50
    v_exp_f32 v51, v51
    v_exp_f32 v52, v52
    v_mfma_f32_32x32x8_bf16 v[32:47], v[114:115], v[20:21], 0
    v_exp_f32 v53, v53
    v_exp_f32 v54, v54
    v_exp_f32 v55, v55
    v_exp_f32 v56, v56
    v_mfma_f32_32x32x16_bf16 v[32:47], v[110:113], v[16:19], v[32:47]
    s_mov_b64 exec, s[22:23]
    buffer_load_dwordx4 v[144:147], v9, s[16:19], s20 offen
    s_mov_b64 exec, -1
    v_exp_f32 v57, v57
    v_exp_f32 v58, v58
    v_exp_f32 v59, v59
    v_smfmac_f32_32x32x32_bf16 v[80:95], v[102:105], v[48:55], v6
    s_mov_b64 exec, s[22:23]
    buffer_load_dwordx4 v[148:151], v162, s[16:19], s20 offen
    s_mov_b64 exec, -1
    s_add_u32 s20, s20, 110592
    s_cmp_eq_u32 s20, s29
    s_cselect_b32 s20, s28, s20
    v_exp_f32 v60, v60
    v_exp_f32 v61, v61
    v_exp_f32 v62, v62
    v_exp_f32 v63, v63
    v_exp_f32 v32, v32
    v_exp_f32 v33, v33
    v_smfmac_f32_32x32x32_bf16 v[80:95], v[106:109], v[56:63], v6
    v_exp_f32 v34, v34
    v_exp_f32 v35, v35
    v_exp_f32 v36, v36
    v_mfma_f32_32x32x8_bf16 v[48:63], v[114:115], v[28:29], 0
    v_exp_f32 v37, v37
    v_exp_f32 v38, v38
    v_exp_f32 v39, v39
    v_exp_f32 v40, v40
    v_mfma_f32_32x32x16_bf16 v[48:63], v[110:113], v[24:27], v[48:63]
    s_cmp_lg_u32 s27, 0
    s_cbranch_scc1 A_CHK
A_CHKD:
    buffer_load_dwordx4 v[96:99], v7, s[16:19], s20 offen
    v_exp_f32 v41, v41
    v_exp_f32 v42, v42
    v_exp_f32 v43, v43
    v_smfmac_f32_32x32x32_bf16 v[64:79], v[116:119], v[32:39], v6
    buffer_load_dwordx2 v[100:101], v8, s[16:19], s20 offen
    v_exp_f32 v44, v44
    v_exp_f32 v45, v45
    v_exp_f32 v46, v46
    v_exp_f32 v47, v47
    v_exp_f32 v48, v48
    v_exp_f32 v49, v49
    v_smfmac_f32_32x32x32_bf16 v[64:79], v[120:123], v[40:47], v6
    s_waitcnt vmcnt(6)
    v_exp_f32 v50, v50
    v_exp_f32 v51, v51
    v_exp_f32 v52, v52
    v_mfma_f32_32x32x8_bf16 v[32:47], v[128:129], v[20:21], 0
    v_exp_f32 v53, v53
    v_exp_f32 v54, v54
    v_exp_f32 v55, v55
    v_exp_f32 v56, v56
    v_mfma_f32_32x32x16_bf16 v[32:47], v[124:127], v[16:19], v[32:47]
    s_mov_b64 exec, s[22:23]
    buffer_load_dwordx4 v[102:105], v9, s[16:19], s20 offen
    s_mov_b64 exec, -1
    v_exp_f32 v57, v57
    v_exp_f32 v58, v58
    v_exp_f32 v59, v59
    v_smfmac_f32_32x32x32_bf16 v[80:95], v[116:119], v[48:55], v6
    s_mov_b64 exec, s[22:23]
    buffer_load_dwordx4 v[106:109], v162, s[16:19], s20 offen
    s_mov_b64 exec, -1
    s_add_u32 s20, s20, 110592
    v_exp_f32 v60, v60
    v_exp_f32 v61, v61
    v_exp_f32 v62, v62
    v_exp_f32 v63, v63
    v_exp_f32 v32, v32
    v_exp_f32 v33, v33
    v_smfmac_f32_32x32x32_bf16 v[80:95], v[120:123], v[56:63], v6
    v_exp_f32 v34, v34
    v_exp_f32 v35, v35
    v_exp_f32 v36, v36
    v_mfma_f32_32x32x8_bf16 v[48:63], v[128:129], v[28:29], 0
    v_exp_f32 v37, v37
    v_exp_f32 v38, v38
    v_exp_f32 v39, v39
    v_exp_f32 v40, v40
    v_mfma_f32_32x32x16_bf16 v[48:63], v[124:127], v[24:27], v[48:63]
    buffer_load_dwordx4 v[110:113], v7, s[16:19], s20 offen
    s_nop 1
    v_exp_f32 v41, v41
    v_exp_f32 v42, v42
    v_exp_f32 v43, v43
    v_smfmac_f32_32x32x32_bf16 v[64:79], v[130:133], v[32:39], v6
    buffer_load_dwordx2 v[114:115], v8, s[16:19], s20 offen
    v_exp_f32 v44, v44
    v_exp_f32 v45, v45
    v_exp_f32 v46, v46
    v_exp_f32 v47, v47
    v_exp_f32 v48, v48
    v_exp_f32 v49, v49
    v_smfmac_f32_32x32x32_bf16 v[64:79], v[134:137], v[40:47], v6
    s_waitcnt vmcnt(6)
    v_exp_f32 v50, v50
    v_exp_f32 v51, v51
    v_exp_f32 v52, v52
    v_mfma_f32_32x32x8_bf16 v[32:47], v[142:143], v[20:21], 0
    v_exp_f32 v53, v53
    v_exp_f32 v54, v54
    v_exp_f32 v55, v55
    v_exp_f32 v56, v56
    v_mfma_f32_32x32x16_bf16 v[32:47], v[138:141], v[16:19], v[32:47]
    s_mov_b64 exec, s[22:23]
    buffer_load_dwordx4 v[116:119], v9, s[16:19], s20 offen
    s_mov_b64 exec, -1
    v_exp_f32 v57, v57
    v_exp_f32 v58, v58
    v_exp_f32 v59, v59
    v_smfmac_f32_32x32x32_bf16 v[80:95], v[130:133], v[48:55], v6
    s_mov_b64 exec, s[22:23]
    buffer_load_dwordx4 v[120:123], v162, s[16:19], s20 offen
    s_mov_b64 exec, -1
    s_add_u32 s20, s20, 110592
    v_exp_f32 v60, v60
    v_exp_f32 v61, v61
    v_exp_f32 v62, v62
    v_exp_f32 v63, v63
    v_exp_f32 v32, v32
    v_exp_f32 v33, v33
    v_smfmac_f32_32x32x32_bf16 v[80:95], v[134:137], v[56:63], v6
    v_exp_f32 v34, v34
    v_exp_f32 v35, v35
    v_exp_f32 v36, v36
    v_mfma_f32_32x32x8_bf16 v[48:63], v[142:143], v[28:29], 0
    v_exp_f32 v37, v37
    v_exp_f32 v38, v38
    v_exp_f32 v39, v39
    v_exp_f32 v40, v40
    v_mfma_f32_32x32x16_bf16 v[48:63], v[138:141], v[24:27], v[48:63]
    buffer_load_dwordx4 v[124:127], v7, s[16:19], s20 offen
    s_nop 1
    v_exp_f32 v41, v41
    v_exp_f32 v42, v42
    v_exp_f32 v43, v43
    v_smfmac_f32_32x32x32_bf16 v[64:79], v[144:147], v[32:39], v6
    buffer_load_dwordx2 v[128:129], v8, s[16:19], s20 offen
    v_exp_f32 v44, v44
    v_exp_f32 v45, v45
    v_exp_f32 v46, v46
    v_exp_f32 v47, v47
    v_exp_f32 v48, v48
    v_exp_f32 v49, v49
    v_smfmac_f32_32x32x32_bf16 v[64:79], v[148:151], v[40:47], v6
    s_waitcnt vmcnt(6)
    v_exp_f32 v50, v50
    v_exp_f32 v51, v51
    v_exp_f32 v52, v52
    v_mfma_f32_32x32x8_bf16 v[32:47], v[100:101], v[20:21], 0
    v_exp_f32 v53, v53
    v_exp_f32 v54, v54
    v_exp_f32 v55, v55
    v_exp_f32 v56, v56
    v_mfma_f32_32x32x16_bf16 v[32:47], v[96:99], v[16:19], v[32:47]
    s_mov_b64 exec, s[22:23]
    buffer_load_dwordx4 v[130:133], v9, s[16:19], s20 offen
    s_mov_b64 exec, -1
    v_exp_f32 v57, v57
    v_exp_f32 v58, v58
    v_exp_f32 v59, v59
    v_smfmac_f32_32x32x32_bf16 v[80:95], v[144:147], v[48:55], v6
    s_mov_b64 exec, s[22:23]
    buffer_load_dwordx4 v[134:137], v162, s[16:19], s20 offen
    s_mov_b64 exec, -1
    s_add_u32 s20, s20, 110592
    s_sub_u32 s21, s21, 1
    s_cmp_lg_u32 s21, 0
    v_exp_f32 v60, v60
    v_exp_f32 v61, v61
    v_exp_f32 v62, v62
    v_exp_f32 v63, v63
    s_cbranch_scc1 A_LOOP
    s_nop 1
    v_smfmac_f32_32x32x32_bf16 v[80:95], v[148:151], v[56:63], v6
A_FINAL:
    s_and_b32 s24, s3, 3
    s_lshl_b32 s25, s24, 4
    v_add_u32 v13, s25, v3
    s_mov_b64 exec, 1
    ds_add_rtn_u32 v2, v13, v1 offset:128
    s_mov_b64 exec, -1
    s_mul_i32 s24, s24, 5632
    s_add_u32 s24, s24, 131072
    v_lshl_add_u32 v10, v0, 4, s24
    v_lshl_add_u32 v12, v0, 2, s24
    v_lshrrev_b32 v15, 1, v4
    v_xor_b32 v15, v15, v4
    v_and_b32 v15, 4, v15
    v_mul_u32_u24 v15, 3, v15
    v_xor_b32 v14, v4, v15
    s_add_u32 s26, s15, 1
    s_waitcnt lgkmcnt(0)
    v_readfirstlane_b32 s96, v2
    s_bitcmp1_b32 s96, 0
    s_cbranch_scc1 A_SECOND
    s_mov_b32 s97, 4194304
LW_19:
    ds_read_b32 v2, v3 offset:36
    s_waitcnt lgkmcnt(0)
    v_readfirstlane_b32 s96, v2
    s_cmp_ge_u32 s96, 1
    s_cbranch_scc1 LWOK_20
    s_sub_u32 s97, s97, 1
    s_cbranch_scc0 LW_19
LWOK_20:
    ds_write_b128 v10, v[64:67] offset:0
    ds_write_b128 v10, v[68:71] offset:1024
    ds_write_b32 v12, v72 offset:2048
    ds_write_b32 v12, v73 offset:2304
    ds_write_b32 v12, v74 offset:2560
    ds_write_b128 v10, v[80:83] offset:2816
    ds_write_b128 v10, v[84:87] offset:3840
    ds_write_b32 v12, v88 offset:4864
    ds_write_b32 v12, v89 offset:5120
    ds_write_b32 v12, v90 offset:5376
    s_waitcnt lgkmcnt(0)
    s_mov_b64 exec, 1
    ds_add_u32 v13, v1 offset:132
    s_mov_b64 exec, -1
    s_waitcnt vmcnt(0)
    s_cmp_lg_u32 s15, 0
    s_cbranch_scc1 A_DONE
    s_mov_b32 s97, 4194304
A_VW:
    ds_read_b32 v2, v13 offset:136
    s_waitcnt lgkmcnt(0)
    v_readfirstlane_b32 s96, v2
    s_cmp_eq_u32 s96, 1
    s_cbranch_scc1 A_DONE
    s_cmp_eq_u32 s96, 2
    s_cbranch_scc1 A_REDO
    s_sleep 2
    s_sub_u32 s97, s97, 1
    s_cbranch_scc0 A_VW
    s_branch A_DONE
A_SECOND:
    s_mov_b32 s97, 4194304
A_RW:
    ds_read_b32 v2, v13 offset:132
    ds_read_b128 v[32:35], v10 offset:0
    ds_read_b128 v[36:39], v10 offset:1024
    ds_read_b32 v40, v12 offset:2048
    ds_read_b32 v41, v12 offset:2304
    ds_read_b32 v42, v12 offset:2560
    ds_read_b128 v[48:51], v10 offset:2816
    ds_read_b128 v[52:55], v10 offset:3840
    ds_read_b32 v56, v12 offset:4864
    ds_read_b32 v57, v12 offset:5120
    ds_read_b32 v58, v12 offset:5376
    s_mul_i32 s27, s30, 36
    s_add_u32 s27, s27, s4
    s_lshl_b32 s27, s27, 10
    s_add_u32 s27, s27, 7077888
    s_add_u32 s25, s27, 36864
    s_lshl_b32 s28, s30, 5
    s_add_u32 s28, s28, s4
    s_lshl_b32 s28, s28, 7
    s_add_u32 s28, s28, 15118336
    v_lshl_add_u32 v15, v5, 5, v14
    v_lshlrev_b32 v15, 4, v15
    v_lshlrev_b32 v11, 12, v5
    v_lshl_add_u32 v11, v14, 2, v11
    s_waitcnt lgkmcnt(0)
    v_readfirstlane_b32 s96, v2
    s_cmp_ge_u32 s96, s26
    s_cbranch_scc1 A_RWOK
    s_sub_u32 s97, s97, 1
    s_cbranch_scc0 A_RW
A_RWOK:
    v_add_f32 v42, v42, v74
    v_add_f32 v58, v58, v90
    v_rcp_f32 v43, v42
    v_rcp_f32 v59, v58
    v_add_f32 v32, v32, v64
    v_add_f32 v33, v33, v65
    v_add_f32 v34, v34, v66
    v_add_f32 v35, v35, v67
    v_add_f32 v36, v36, v68
    v_add_f32 v37, v37, v69
    v_add_f32 v38, v38, v70
    v_add_f32 v39, v39, v71
    v_add_f32 v40, v40, v72
    v_add_f32 v41, v41, v73
    v_mul_f32 v64, v32, v43
    v_mul_f32 v65, v33, v43
    v_mul_f32 v66, v34, v43
    v_mul_f32 v67, v35, v43
    v_mul_f32 v68, v36, v43
    v_mul_f32 v69, v37, v43
    v_mul_f32 v70, v38, v43
    v_mul_f32 v71, v39, v43
    v_mul_f32 v72, v40, v43
    v_mul_f32 v73, v41, v43
    v_cvt_pk_bf16_f32 v64, v64, v65
    v_cvt_pk_bf16_f32 v65, v66, v67
    v_cvt_pk_bf16_f32 v66, v68, v69
    v_cvt_pk_bf16_f32 v67, v70, v71
    v_cvt_pk_bf16_f32 v68, v72, v73
    buffer_store_dwordx4 v[64:67], v15, s[16:19], s27 offen sc1
    v_add_f32 v48, v48, v80
    v_add_f32 v49, v49, v81
    v_add_f32 v50, v50, v82
    v_add_f32 v51, v51, v83
    v_add_f32 v52, v52, v84
    v_add_f32 v53, v53, v85
    v_add_f32 v54, v54, v86
    v_add_f32 v55, v55, v87
    v_add_f32 v56, v56, v88
    v_add_f32 v57, v57, v89
    v_mul_f32 v80, v48, v59
    v_mul_f32 v81, v49, v59
    v_mul_f32 v82, v50, v59
    v_mul_f32 v83, v51, v59
    v_mul_f32 v84, v52, v59
    v_mul_f32 v85, v53, v59
    v_mul_f32 v86, v54, v59
    v_mul_f32 v87, v55, v59
    v_mul_f32 v88, v56, v59
    v_mul_f32 v89, v57, v59
    v_cvt_pk_bf16_f32 v80, v80, v81
    v_cvt_pk_bf16_f32 v81, v82, v83
    v_cvt_pk_bf16_f32 v82, v84, v85
    v_cvt_pk_bf16_f32 v83, v86, v87
    v_cvt_pk_bf16_f32 v84, v88, v89
    buffer_store_dwordx4 v[80:83], v15, s[16:19], s25 offen sc1
    s_nop 0
    v_permlane32_swap_b32 v68, v84
    buffer_store_dword v68, v11, s[16:19], s28 offen sc1
    v_fma_f32 v42, v32, 0, v42
    v_fma_f32 v58, v48, 0, v58
    v_fma_f32 v42, v33, 0, v42
    v_fma_f32 v58, v49, 0, v58
    v_fma_f32 v42, v34, 0, v42
    v_fma_f32 v58, v50, 0, v58
    v_fma_f32 v42, v35, 0, v42
    v_fma_f32 v58, v51, 0, v58
    v_fma_f32 v42, v36, 0, v42
    v_fma_f32 v58, v52, 0, v58
    v_fma_f32 v42, v37, 0, v42
    v_fma_f32 v58, v53, 0, v58
    v_fma_f32 v42, v38, 0, v42
    v_fma_f32 v58, v54, 0, v58
    v_fma_f32 v42, v39, 0, v42
    v_fma_f32 v58, v55, 0, v58
    v_fma_f32 v42, v40, 0, v42
    v_fma_f32 v58, v56, 0, v58
    v_fma_f32 v42, v41, 0, v42
    v_fma_f32 v58, v57, 0, v58
    s_mov_b32 s28, 0x21800000
    s_mov_b32 s29, 0x5d800000
    v_cmp_le_f32 vcc, s28, v42
    v_cmp_ge_f32 s[24:25], s29, v42
    v_cmp_le_f32 s[26:27], s28, v58
    v_cmp_ge_f32 s[28:29], s29, v58
    s_and_b64 vcc, vcc, s[24:25]
    s_and_b64 vcc, vcc, s[26:27]
    s_and_b64 vcc, vcc, s[28:29]
    s_lshl_b32 s24, s30, 4
    s_add_u32 s24, s24, s4
    s_lshl_b32 s24, s24, 7
    s_add_u32 s24, s24, 14954496
    s_cmp_eq_u64 vcc, -1
    s_cselect_b32 s25, 1, 2
    s_cmp_lg_u32 s15, 0
    s_cselect_b32 s25, 1, s25
    v_mov_b32 v11, s25
    ds_write_b32 v13, v11 offset:136
    s_cmp_eq_u32 s25, 1
    s_cbranch_scc1 A_PUB
A_REDO:
    s_mov_b32 s15, 1
    s_mov_b32 s20, 0
    s_mov_b32 s21, 64
    v_mov_b32 v165, 0xff800000
    v_mov_b32 v166, 0xff800000
    s_waitcnt vmcnt(0)
A_MAXLOOP:
    buffer_load_dwordx4 v[96:99], v7, s[16:19], s20 offen
    buffer_load_dwordx2 v[100:101], v8, s[16:19], s20 offen
    s_add_u32 s20, s20, 110592
    s_waitcnt vmcnt(0)
    v_mfma_f32_32x32x8_bf16 v[32:47], v[100:101], v[20:21], 0
    v_mfma_f32_32x32x16_bf16 v[32:47], v[96:99], v[16:19], v[32:47]
    v_mfma_f32_32x32x8_bf16 v[48:63], v[100:101], v[28:29], 0
    v_mfma_f32_32x32x16_bf16 v[48:63], v[96:99], v[24:27], v[48:63]
    s_nop 15
    v_max3_f32 v165, v165, v32, v33
    v_max3_f32 v166, v166, v48, v49
    v_max3_f32 v165, v165, v34, v35
    v_max3_f32 v166, v166, v50, v51
    v_max3_f32 v165, v165, v36, v37
    v_max3_f32 v166, v166, v52, v53
    v_max3_f32 v165, v165, v38, v39
    v_max3_f32 v166, v166, v54, v55
    v_max3_f32 v165, v165, v40, v41
    v_max3_f32 v166, v166, v56, v57
    v_max3_f32 v165, v165, v42, v43
    v_max3_f32 v166, v166, v58, v59
    v_max3_f32 v165, v165, v44, v45
    v_max3_f32 v166, v166, v60, v61
    v_max3_f32 v165, v165, v46, v47
    v_max3_f32 v166, v166, v62, v63
    s_sub_u32 s21, s21, 1
    s_cmp_lg_u32 s21, 0
    s_cbranch_scc1 A_MAXLOOP
    v_mov_b32 v12, v165
    s_nop 1
    v_permlane32_swap_b32 v12, v165
    s_nop 1
    v_max_f32 v165, v165, v12
    v_mov_b32 v12, v166
    s_nop 1
    v_permlane32_swap_b32 v12, v166
    s_nop 1
    v_max_f32 v166, v166, v12
    v_mov_b32 v64, 0
    v_mov_b32 v80, 0
    v_mov_b32 v65, 0
    v_mov_b32 v81, 0
    v_mov_b32 v66, 0
    v_mov_b32 v82, 0
    v_mov_b32 v67, 0
    v_mov_b32 v83, 0
    v_mov_b32 v68, 0
    v_mov_b32 v84, 0
    v_mov_b32 v69, 0
    v_mov_b32 v85, 0
    v_mov_b32 v70, 0
    v_mov_b32 v86, 0
    v_mov_b32 v71, 0
    v_mov_b32 v87, 0
    v_mov_b32 v72, 0
    v_mov_b32 v88, 0
    v_mov_b32 v73, 0
    v_mov_b32 v89, 0
    v_mov_b32 v74, 0
    v_mov_b32 v90, 0
    v_mov_b32 v75, 0
    v_mov_b32 v91, 0
    v_mov_b32 v76, 0
    v_mov_b32 v92, 0
    v_mov_b32 v77, 0
    v_mov_b32 v93, 0
    v_mov_b32 v78, 0
    v_mov_b32 v94, 0
    v_mov_b32 v79, 0
    v_mov_b32 v95, 0
    s_mov_b32 s20, s14
    s_mov_b32 s21, 32
A_SLOWLOOP:
    buffer_load_dwordx4 v[96:99], v7, s[16:19], s20 offen
    buffer_load_dwordx2 v[100:101], v8, s[16:19], s20 offen
    s_mov_b64 exec, s[22:23]
    buffer_load_dwordx4 v[102:105], v9, s[16:19], s20 offen
    buffer_load_dwordx4 v[106:109], v162, s[16:19], s20 offen
    s_mov_b64 exec, -1
    s_add_u32 s20, s20, 110592
    s_waitcnt vmcnt(0)
    v_mfma_f32_32x32x8_bf16 v[32:47], v[100:101], v[20:21], 0
    v_mfma_f32_32x32x16_bf16 v[32:47], v[96:99], v[16:19], v[32:47]
    v_mfma_f32_32x32x8_bf16 v[48:63], v[100:101], v[28:29], 0
    v_mfma_f32_32x32x16_bf16 v[48:63], v[96:99], v[24:27], v[48:63]
    s_nop 15
    v_sub_f32 v32, v32, v165
    v_sub_f32 v48, v48, v166
    v_sub_f32 v33, v33, v165
    v_sub_f32 v49, v49, v166
    v_sub_f32 v34, v34, v165
    v_sub_f32 v50, v50, v166
    v_sub_f32 v35, v35, v165
    v_sub_f32 v51, v51, v166
    v_sub_f32 v36, v36, v165
    v_sub_f32 v52, v52, v166
    v_sub_f32 v37, v37, v165
    v_sub_f32 v53, v53, v166
    v_sub_f32 v38, v38, v165
    v_sub_f32 v54, v54, v166
    v_sub_f32 v39, v39, v165
    v_sub_f32 v55, v55, v166
    v_sub_f32 v40, v40, v165
    v_sub_f32 v56, v56, v166
    v_sub_f32 v41, v41, v165
    v_sub_f32 v57, v57, v166
    v_sub_f32 v42, v42, v165
    v_sub_f32 v58, v58, v166
    v_sub_f32 v43, v43, v165
    v_sub_f32 v59, v59, v166
    v_sub_f32 v44, v44, v165
    v_sub_f32 v60, v60, v166
    v_sub_f32 v45, v45, v165
    v_sub_f32 v61, v61, v166
    v_sub_f32 v46, v46, v165
    v_sub_f32 v62, v62, v166
    v_sub_f32 v47, v47, v165
    v_sub_f32 v63, v63, v166
    v_exp_f32 v32, v32
    v_exp_f32 v33, v33
    v_exp_f32 v34, v34
    v_exp_f32 v35, v35
    v_exp_f32 v36, v36
    v_exp_f32 v37, v37
    v_exp_f32 v38, v38
    v_exp_f32 v39, v39
    v_exp_f32 v40, v40
    v_exp_f32 v41, v41
    v_exp_f32 v42, v42
    v_exp_f32 v43, v43
    v_exp_f32 v44, v44
    v_exp_f32 v45, v45
    v_exp_f32 v46, v46
    v_exp_f32 v47, v47
    v_exp_f32 v48, v48
    v_exp_f32 v49, v49
    v_exp_f32 v50, v50
    v_exp_f32 v51, v51
    v_exp_f32 v52, v52
    v_exp_f32 v53, v53
    v_exp_f32 v54, v54
    v_exp_f32 v55, v55
    v_exp_f32 v56, v56
    v_exp_f32 v57, v57
    v_exp_f32 v58, v58
    v_exp_f32 v59, v59
    v_exp_f32 v60, v60
    v_exp_f32 v61, v61
    v_exp_f32 v62, v62
    v_exp_f32 v63, v63
    s_nop 1
    v_smfmac_f32_32x32x32_bf16 v[64:79], v[102:105], v[32:39], v6
    v_smfmac_f32_32x32x32_bf16 v[80:95], v[102:105], v[48:55], v6
    v_smfmac_f32_32x32x32_bf16 v[64:79], v[106:109], v[40:47], v6
    v_smfmac_f32_32x32x32_bf16 v[80:95], v[106:109], v[56:63], v6
    s_sub_u32 s21, s21, 1
    s_cmp_lg_u32 s21, 0
    s_cbranch_scc1 A_SLOWLOOP
    s_branch A_FINAL
A_PRIO:
    s_setprio 1
    s_cmp_eq_u32 s21, 4
    s_cbranch_scc1 A_PRIOD
    s_setprio 0
    s_cmp_eq_u32 s21, 1
    s_cbranch_scc1 A_PRIOD
    s_branch A_PRIOD
A_CHK:
    s_mov_b32 s27, 0
    s_waitcnt vmcnt(4)
    v_cmp_ne_u32 vcc, s74, v161
    s_cmp_eq_u64 vcc, 0
    s_cbranch_scc1 A_CHKD
    s_mov_b32 s97, 262144
FW_21:
    buffer_load_dword v161, v160, s[16:19], 0 offen sc1
    s_waitcnt vmcnt(0)
    v_xor_b32 v161, s74, v161
    v_cmp_ne_u32 vcc, 0, v161
    s_cmp_eq_u64 vcc, 0
    s_cbranch_scc1 FWOK_22
    s_sleep 1
    s_sub_u32 s97, s97, 1
    s_cbranch_scc0 FW_21
FWOK_22:
    s_branch A_CHKD
A_PUB:
    s_waitcnt vmcnt(0)
    v_mov_b32 v10, 0
    v_mov_b32 v11, s74
    s_mov_b64 exec, 1
    buffer_store_dword v11, v10, s[16:19], s24 offen sc1
    s_mov_b64 exec, -1
A_DONE:
F_P3:
    s_cmp_ge_u32 s2, 192
    s_cbranch_scc1 F_FIN
    s_and_b32 s4, s2, 7
    s_lshl_b32 s4, s4, 2
    s_bfe_u32 s5, s2, 0x20003
    s_add_u32 s4, s4, s5
    s_lshr_b32 s5, s2, 5
    s_and_b32 s6, s3, 1
    s_lshr_b32 s7, s3, 1
    s_lshl_b32 s8, s4, 1
    s_add_u32 s8, s8, s6
    v_lshlrev_b32 v6, 4, v0
    s_cmp_eq_u32 s7, 3
    s_cselect_b32 s9, 0, s7
    s_add_u32 s10, s9, 1
    s_cmp_eq_u32 s10, 3
    s_cselect_b32 s10, 0, s10
    s_add_u32 s11, s10, 1
    s_cmp_eq_u32 s11, 3
    s_cselect_b32 s11, 0, s11
    s_lshl_b32 s12, s7, 13
    v_bfe_u32 v12, v0, 2, 2
    v_lshl_add_u32 v13, v5, 2, v12
    v_lshrrev_b32 v14, 1, v12
    v_lshl_add_u32 v14, v5, 2, v14
    v_mul_u32_u24 v14, 18, v14
    v_and_b32 v12, 1, v12
    v_add3_u32 v14, v14, v12, 16
    v_sub_u32 v14, v14, v13
    v_mul_u32_u24 v14, 192, v14
    v_mul_u32_u24 v13, 192, v13
    v_bfe_u32 v12, v0, 4, 1
    v_lshl_add_u32 v13, v12, 5, v13
    v_and_b32 v12, 3, v0
    v_lshl_add_u32 v13, v12, 3, v13
    s_mul_i32 s26, s7, 27648
    s_lshl_b32 s13, s9, 6
    s_add_u32 s13, s13, s26
    v_add_u32 v8, s13, v13
    s_lshl_b32 s13, s10, 6
    s_add_u32 s13, s13, s26
    v_add_u32 v9, s13, v13
    s_lshl_b32 s13, s11, 6
    s_add_u32 s13, s13, s26
    v_add_u32 v10, s13, v13
    s_mov_b32 s97, 4194304
LW_23:
    ds_read_b32 v2, v3 offset:108
    s_waitcnt lgkmcnt(0)
    v_readfirstlane_b32 s96, v2
    s_cmp_ge_u32 s96, 1
    s_cbranch_scc1 LWOK_24
    s_sleep 1
    s_sub_u32 s97, s97, 1
    s_cbranch_scc0 LW_23
LWOK_24:
    s_mul_i32 s13, s6, 6144
    s_lshl_b32 s14, s9, 11
    s_add_u32 s13, s13, s14
    s_add_u32 s13, s13, 110592
    v_lshlrev_b32 v7, 6, v4
    v_lshl_add_u32 v7, v5, 4, v7
    v_add_u32 v7, s13, v7
    ds_read_b128 v[16:19], v7
    ds_read_b128 v[20:23], v7 offset:32
    s_lshl_b32 s13, s6, 8
    s_add_u32 s13, s13, 122880
    v_lshl_add_u32 v7, v4, 3, s13
    ds_read_b64 v[12:13], v7
    v_lshlrev_b32 v32, 3, v5
    v_sub_u32 v32, v4, v32
    v_and_b32 v33, 1, v32
    v_lshlrev_b32 v33, 4, v33
    v_mov_b32 v34, 0x3f80
    v_lshlrev_b32 v33, v33, v34
    v_ashrrev_i32 v34, 1, v32
    v_cmp_eq_u32 s[60:61], 0, v34
    v_cmp_eq_u32 s[62:63], 1, v34
    v_cmp_eq_u32 s[64:65], 2, v34
    v_cmp_eq_u32 s[66:67], 3, v34
    s_nop 1
    v_cndmask_b32 v24, 0, v33, s[60:61]
    v_cndmask_b32 v25, 0, v33, s[62:63]
    v_cndmask_b32 v26, 0, v33, s[64:65]
    v_cndmask_b32 v27, 0, v33, s[66:67]
    v_subrev_u32 v32, 16, v32
    v_and_b32 v33, 1, v32
    v_lshlrev_b32 v33, 4, v33
    v_mov_b32 v34, 0x3f80
    v_lshlrev_b32 v33, v33, v34
    v_ashrrev_i32 v34, 1, v32
    v_cmp_eq_u32 s[60:61], 0, v34
    v_cmp_eq_u32 s[62:63], 1, v34
    v_cmp_eq_u32 s[64:65], 2, v34
    v_cmp_eq_u32 s[66:67], 3, v34
    s_nop 1
    v_cndmask_b32 v28, 0, v33, s[60:61]
    v_cndmask_b32 v29, 0, v33, s[62:63]
    v_cndmask_b32 v30, 0, v33, s[64:65]
    v_cndmask_b32 v31, 0, v33, s[66:67]
    s_waitcnt lgkmcnt(0)
    v_mfma_f32_32x32x16_bf16 v[148:163], v[16:19], v[24:27], 0
    v_mfma_f32_32x32x16_bf16 v[148:163], v[20:23], v[28:31], v[148:163]
    ds_read_b64_tr_b16 v[100:101], v8 offset:0
    ds_read_b64_tr_b16 v[102:103], v8 offset:1536
    ds_read_b64_tr_b16 v[104:105], v9 offset:0
    ds_read_b64_tr_b16 v[106:107], v9 offset:1536
    ds_read_b64_tr_b16 v[108:109], v10 offset:0
    ds_read_b64_tr_b16 v[110:111], v10 offset:1536
    ds_read_b64_tr_b16 v[112:113], v8 offset:3456
    ds_read_b64_tr_b16 v[114:115], v8 offset:4992
    ds_read_b64_tr_b16 v[116:117], v9 offset:3456
    ds_read_b64_tr_b16 v[118:119], v9 offset:4992
    ds_read_b64_tr_b16 v[120:121], v10 offset:3456
    ds_read_b64_tr_b16 v[122:123], v10 offset:4992
    ds_read_b64_tr_b16 v[124:125], v8 offset:6912
    ds_read_b64_tr_b16 v[126:127], v8 offset:8448
    ds_read_b64_tr_b16 v[128:129], v9 offset:6912
    ds_read_b64_tr_b16 v[130:131], v9 offset:8448
    ds_read_b64_tr_b16 v[132:133], v10 offset:6912
    ds_read_b64_tr_b16 v[134:135], v10 offset:8448
    ds_read_b64_tr_b16 v[136:137], v8 offset:10368
    ds_read_b64_tr_b16 v[138:139], v8 offset:11904
    ds_read_b64_tr_b16 v[140:141], v9 offset:10368
    ds_read_b64_tr_b16 v[142:143], v9 offset:11904
    ds_read_b64_tr_b16 v[144:145], v10 offset:10368
    ds_read_b64_tr_b16 v[146:147], v10 offset:11904
    s_lshl_b32 s13, s4, 2
    s_add_u32 s13, s13, s7
    s_lshl_b32 s13, s13, 10
    s_add_u32 s13, s13, 14954496
    v_and_b32 v11, 7, v0
    v_lshl_add_u32 v11, v11, 7, s13
    s_mul_i32 s14, s8, 36864
    s_add_u32 s14, s14, s12
    s_add_u32 s14, s14, 7077888
    s_add_u32 s24, s14, 4096
    s_lshl_b32 s25, s8, 2
    s_add_u32 s25, s25, s7
    s_lshl_b32 s25, s25, 10
    s_add_u32 s25, s25, 15118336
    v_lshlrev_b32 v7, 9, v5
    v_lshl_add_u32 v7, v4, 2, v7
    s_mov_b32 s27, 0xffff0000
    v_mul_f32 v148, v148, v12
    v_mul_f32 v149, v149, v12
    v_mul_f32 v150, v150, v12
    v_mul_f32 v151, v151, v12
    v_mul_f32 v152, v152, v12
    v_mul_f32 v153, v153, v12
    v_mul_f32 v154, v154, v12
    v_mul_f32 v155, v155, v12
    v_mul_f32 v156, v156, v12
    v_mul_f32 v157, v157, v12
    v_mul_f32 v158, v158, v12
    v_mul_f32 v159, v159, v12
    v_mul_f32 v160, v160, v12
    v_mul_f32 v161, v161, v12
    v_mul_f32 v162, v162, v12
    v_mul_f32 v163, v163, v12
    v_cvt_pk_bf16_f32 v148, v148, v149
    v_cvt_pk_bf16_f32 v150, v150, v151
    v_cvt_pk_bf16_f32 v152, v152, v153
    v_cvt_pk_bf16_f32 v154, v154, v155
    v_cvt_pk_bf16_f32 v156, v156, v157
    v_cvt_pk_bf16_f32 v158, v158, v159
    v_cvt_pk_bf16_f32 v160, v160, v161
    v_cvt_pk_bf16_f32 v162, v162, v163
    v_and_b32 v149, s27, v148
    v_lshlrev_b32 v148, 16, v148
    v_and_b32 v151, s27, v150
    v_lshlrev_b32 v150, 16, v150
    v_and_b32 v153, s27, v152
    v_lshlrev_b32 v152, 16, v152
    v_and_b32 v155, s27, v154
    v_lshlrev_b32 v154, 16, v154
    v_and_b32 v157, s27, v156
    v_lshlrev_b32 v156, 16, v156
    v_and_b32 v159, s27, v158
    v_lshlrev_b32 v158, 16, v158
    v_and_b32 v161, s27, v160
    v_lshlrev_b32 v160, 16, v160
    v_and_b32 v163, s27, v162
    v_lshlrev_b32 v162, 16, v162
    s_mul_i32 s20, s6, 36864
    s_sub_u32 s21, s7, s9
    s_sub_u32 s21, s21, 1
    s_and_b32 s21, s21, 3
    s_lshl_b32 s21, s21, 12
    s_mul_i32 s22, s9, 12288
    s_add_u32 s21, s21, s22
    s_add_u32 s21, s21, s20
    v_add_u32 v164, s21, v6
    s_sub_u32 s21, s7, s10
    s_sub_u32 s21, s21, 1
    s_and_b32 s21, s21, 3
    s_lshl_b32 s21, s21, 12
    s_mul_i32 s22, s10, 12288
    s_add_u32 s21, s21, s22
    s_add_u32 s21, s21, s20
    v_add_u32 v165, s21, v6
    s_sub_u32 s21, s7, s11
    s_sub_u32 s21, s21, 1
    s_and_b32 s21, s21, 3
    s_lshl_b32 s21, s21, 12
    s_mul_i32 s22, s11, 12288
    s_add_u32 s21, s21, s22
    s_add_u32 s21, s21, s20
    v_add_u32 v166, s21, v6
    s_mul_i32 s21, s9, 12288
    s_add_u32 s21, s21, s20
    v_add_u32 v167, s21, v6
    s_mov_b32 s20, s54
    s_mov_b32 s21, s55
    s_mov_b32 s22, 2359296
    s_mov_b32 s23, 0x20000
    s_lshl_b32 s28, s8, 5
    v_add_u32 v15, s28, v4
    v_mul_u32_u24 v15, 1152, v15
    v_lshl_add_u32 v15, v5, 4, v15
    s_mul_i32 s28, s5, 3
    s_add_u32 s28, s28, s9
    s_lshl_b32 s28, s28, 6
    s_mov_b32 s97, 262144
FW_25:
    buffer_load_dword v2, v11, s[16:19], 0 offen sc1
    s_waitcnt vmcnt(0)
    v_xor_b32 v2, s74, v2
    v_cmp_ne_u32 vcc, 0, v2
    s_cmp_eq_u64 vcc, 0
    s_cbranch_scc1 FWOK_26
    s_sleep 1
    s_sub_u32 s97, s97, 1
    s_cbranch_scc0 FW_25
FWOK_26:
    buffer_load_dwordx4 v[64:67], v6, s[16:19], s14 offen offset:0 sc1
    buffer_load_dwordx4 v[68:71], v6, s[16:19], s14 offen offset:1024 sc1
    buffer_load_dwordx4 v[72:75], v6, s[16:19], s14 offen offset:2048 sc1
    buffer_load_dwordx4 v[76:79], v6, s[16:19], s14 offen offset:3072 sc1
    buffer_load_dwordx4 v[80:83], v6, s[16:19], s24 offen offset:0 sc1
    buffer_load_dwordx4 v[84:87], v6, s[16:19], s24 offen offset:1024 sc1
    buffer_load_dwordx4 v[88:91], v6, s[16:19], s24 offen offset:2048 sc1
    buffer_load_dwordx4 v[92:95], v6, s[16:19], s24 offen offset:3072 sc1
    buffer_load_dword v96, v7, s[16:19], s25 offen offset:0 sc1
    buffer_load_dword v97, v7, s[16:19], s25 offen offset:128 sc1
    buffer_load_dword v98, v7, s[16:19], s25 offen offset:256 sc1
    buffer_load_dword v99, v7, s[16:19], s25 offen offset:384 sc1
    s_waitcnt vmcnt(11) lgkmcnt(15)
    v_mfma_f32_32x32x16_bf16 v[32:47], v[104:107], v[64:67], 0
    v_mfma_f32_32x32x16_bf16 v[48:63], v[108:111], v[64:67], 0
    v_mfma_f32_32x32x16_bf16 v[16:31], v[100:103], v[64:67], 0
    ds_read_b64_tr_b16 v[100:101], v8 offset:13824
    ds_read_b64_tr_b16 v[102:103], v8 offset:15360
    ds_read_b64_tr_b16 v[104:105], v9 offset:13824
    ds_read_b64_tr_b16 v[106:107], v9 offset:15360
    ds_read_b64_tr_b16 v[108:109], v10 offset:13824
    ds_read_b64_tr_b16 v[110:111], v10 offset:15360
    s_waitcnt vmcnt(10) lgkmcnt(15)
    v_mfma_f32_32x32x16_bf16 v[32:47], v[116:119], v[68:71], v[32:47]
    v_mfma_f32_32x32x16_bf16 v[48:63], v[120:123], v[68:71], v[48:63]
    v_mfma_f32_32x32x16_bf16 v[16:31], v[112:115], v[68:71], v[16:31]
    ds_read_b64_tr_b16 v[112:113], v8 offset:17280
    ds_read_b64_tr_b16 v[114:115], v8 offset:18816
    ds_read_b64_tr_b16 v[116:117], v9 offset:17280
    ds_read_b64_tr_b16 v[118:119], v9 offset:18816
    ds_read_b64_tr_b16 v[120:121], v10 offset:17280
    ds_read_b64_tr_b16 v[122:123], v10 offset:18816
    s_waitcnt vmcnt(9) lgkmcnt(15)
    v_mfma_f32_32x32x16_bf16 v[32:47], v[128:131], v[72:75], v[32:47]
    v_mfma_f32_32x32x16_bf16 v[48:63], v[132:135], v[72:75], v[48:63]
    v_mfma_f32_32x32x16_bf16 v[16:31], v[124:127], v[72:75], v[16:31]
    ds_read_b64_tr_b16 v[124:125], v8 offset:20736
    ds_read_b64_tr_b16 v[126:127], v8 offset:22272
    ds_read_b64_tr_b16 v[128:129], v9 offset:20736
    ds_read_b64_tr_b16 v[130:131], v9 offset:22272
    ds_read_b64_tr_b16 v[132:133], v10 offset:20736
    ds_read_b64_tr_b16 v[134:135], v10 offset:22272
    s_waitcnt vmcnt(8) lgkmcnt(15)
    v_mfma_f32_32x32x16_bf16 v[32:47], v[140:143], v[76:79], v[32:47]
    v_mfma_f32_32x32x16_bf16 v[48:63], v[144:147], v[76:79], v[48:63]
    v_mfma_f32_32x32x16_bf16 v[16:31], v[136:139], v[76:79], v[16:31]
    ds_read_b64_tr_b16 v[136:137], v8 offset:24192
    ds_read_b64_tr_b16 v[138:139], v8 offset:25728
    ds_read_b64_tr_b16 v[140:141], v9 offset:24192
    ds_read_b64_tr_b16 v[142:143], v9 offset:25728
    ds_read_b64_tr_b16 v[144:145], v10 offset:24192
    ds_read_b64_tr_b16 v[146:147], v10 offset:25728
    s_waitcnt vmcnt(7) lgkmcnt(15)
    v_mfma_f32_32x32x16_bf16 v[32:47], v[104:107], v[80:83], v[32:47]
    v_mfma_f32_32x32x16_bf16 v[48:63], v[108:111], v[80:83], v[48:63]
    v_mfma_f32_32x32x16_bf16 v[16:31], v[100:103], v[80:83], v[16:31]
    v_add_u32 v8, v14, v8
    ds_read_b64_tr_b16 v[100:101], v8 offset:0
    ds_read_b64_tr_b16 v[102:103], v8 offset:6912
    v_add_u32 v9, v14, v9
    ds_read_b64_tr_b16 v[104:105], v9 offset:0
    ds_read_b64_tr_b16 v[106:107], v9 offset:6912
    v_add_u32 v10, v14, v10
    ds_read_b64_tr_b16 v[108:109], v10 offset:0
    ds_read_b64_tr_b16 v[110:111], v10 offset:6912
    s_waitcnt vmcnt(6) lgkmcnt(15)
    v_mfma_f32_32x32x16_bf16 v[32:47], v[116:119], v[84:87], v[32:47]
    v_mfma_f32_32x32x16_bf16 v[48:63], v[120:123], v[84:87], v[48:63]
    v_mfma_f32_32x32x16_bf16 v[16:31], v[112:115], v[84:87], v[16:31]
    s_waitcnt vmcnt(5) lgkmcnt(12)
    v_mfma_f32_32x32x16_bf16 v[32:47], v[128:131], v[88:91], v[32:47]
    v_mfma_f32_32x32x16_bf16 v[48:63], v[132:135], v[88:91], v[48:63]
    v_mfma_f32_32x32x16_bf16 v[16:31], v[124:127], v[88:91], v[16:31]
    s_waitcnt vmcnt(4) lgkmcnt(6)
    v_mfma_f32_32x32x16_bf16 v[32:47], v[140:143], v[92:95], v[32:47]
    v_mfma_f32_32x32x16_bf16 v[48:63], v[144:147], v[92:95], v[48:63]
    v_mfma_f32_32x32x16_bf16 v[16:31], v[136:139], v[92:95], v[16:31]
    s_waitcnt vmcnt(0) lgkmcnt(0)
    v_mfma_f32_32x32x16_bf16 v[32:47], v[104:107], v[96:99], v[32:47]
    v_mfma_f32_32x32x16_bf16 v[48:63], v[108:111], v[96:99], v[48:63]
    v_mfma_f32_32x32x16_bf16 v[16:31], v[100:103], v[96:99], v[16:31]
    s_barrier
    s_nop 8
    ds_write_b128 v165, v[32:35] offset:0
    ds_write_b128 v165, v[36:39] offset:1024
    ds_write_b128 v165, v[40:43] offset:2048
    ds_write_b128 v165, v[44:47] offset:3072
    ds_write_b128 v166, v[48:51] offset:0
    ds_write_b128 v166, v[52:55] offset:1024
    ds_write_b128 v166, v[56:59] offset:2048
    ds_write_b128 v166, v[60:63] offset:3072
    s_cmp_lg_u32 s7, 3
    s_cbranch_scc1 P_OWN
    ds_write_b128 v164, v[16:19] offset:0
    ds_write_b128 v164, v[20:23] offset:1024
    ds_write_b128 v164, v[24:27] offset:2048
    ds_write_b128 v164, v[28:31] offset:3072
    s_waitcnt lgkmcnt(0)
    s_barrier
    s_branch F_FIN
P_OWN:
    s_waitcnt lgkmcnt(0)
    s_barrier
    ds_read_b128 v[64:67], v167 offset:0
    ds_read_b128 v[68:71], v167 offset:1024
    ds_read_b128 v[72:75], v167 offset:2048
    ds_read_b128 v[76:79], v167 offset:3072
    ds_read_b128 v[80:83], v167 offset:4096
    ds_read_b128 v[84:87], v167 offset:5120
    ds_read_b128 v[88:91], v167 offset:6144
    ds_read_b128 v[92:95], v167 offset:7168
    ds_read_b128 v[96:99], v167 offset:8192
    ds_read_b128 v[100:103], v167 offset:9216
    ds_read_b128 v[104:107], v167 offset:10240
    ds_read_b128 v[108:111], v167 offset:11264
    s_waitcnt lgkmcnt(8)
    v_pk_add_f32 v[16:17], v[16:17], v[64:65]
    v_pk_add_f32 v[18:19], v[18:19], v[66:67]
    v_pk_add_f32 v[20:21], v[20:21], v[68:69]
    v_pk_add_f32 v[22:23], v[22:23], v[70:71]
    v_pk_add_f32 v[24:25], v[24:25], v[72:73]
    v_pk_add_f32 v[26:27], v[26:27], v[74:75]
    v_pk_add_f32 v[28:29], v[28:29], v[76:77]
    v_pk_add_f32 v[30:31], v[30:31], v[78:79]
    s_waitcnt lgkmcnt(4)
    v_pk_add_f32 v[16:17], v[16:17], v[80:81]
    v_pk_add_f32 v[18:19], v[18:19], v[82:83]
    v_pk_add_f32 v[20:21], v[20:21], v[84:85]
    v_pk_add_f32 v[22:23], v[22:23], v[86:87]
    v_pk_add_f32 v[24:25], v[24:25], v[88:89]
    v_pk_add_f32 v[26:27], v[26:27], v[90:91]
    v_pk_add_f32 v[28:29], v[28:29], v[92:93]
    v_pk_add_f32 v[30:31], v[30:31], v[94:95]
    s_waitcnt lgkmcnt(0)
    v_pk_add_f32 v[16:17], v[16:17], v[96:97]
    v_pk_add_f32 v[18:19], v[18:19], v[98:99]
    v_pk_add_f32 v[20:21], v[20:21], v[100:101]
    v_pk_add_f32 v[22:23], v[22:23], v[102:103]
    v_pk_add_f32 v[24:25], v[24:25], v[104:105]
    v_pk_add_f32 v[26:27], v[26:27], v[106:107]
    v_pk_add_f32 v[28:29], v[28:29], v[108:109]
    v_pk_add_f32 v[30:31], v[30:31], v[110:111]
    v_cvt_pk_bf16_f32 v16, v16, v17
    v_cvt_pk_bf16_f32 v18, v18, v19
    v_cvt_pk_bf16_f32 v20, v20, v21
    v_cvt_pk_bf16_f32 v22, v22, v23
    v_cvt_pk_bf16_f32 v24, v24, v25
    v_cvt_pk_bf16_f32 v26, v26, v27
    v_cvt_pk_bf16_f32 v28, v28, v29
    v_cvt_pk_bf16_f32 v30, v30, v31
    v_and_b32 v17, s27, v16
    v_lshlrev_b32 v16, 16, v16
    v_and_b32 v19, s27, v18
    v_lshlrev_b32 v18, 16, v18
    v_and_b32 v21, s27, v20
    v_lshlrev_b32 v20, 16, v20
    v_and_b32 v23, s27, v22
    v_lshlrev_b32 v22, 16, v22
    v_and_b32 v25, s27, v24
    v_lshlrev_b32 v24, 16, v24
    v_and_b32 v27, s27, v26
    v_lshlrev_b32 v26, 16, v26
    v_and_b32 v29, s27, v28
    v_lshlrev_b32 v28, 16, v28
    v_and_b32 v31, s27, v30
    v_lshlrev_b32 v30, 16, v30
    v_pk_mul_f32 v[16:17], v[16:17], v[12:13] op_sel:[0,1] op_sel_hi:[1,1]
    v_pk_mul_f32 v[18:19], v[18:19], v[12:13] op_sel:[0,1] op_sel_hi:[1,1]
    v_pk_mul_f32 v[20:21], v[20:21], v[12:13] op_sel:[0,1] op_sel_hi:[1,1]
    v_pk_mul_f32 v[22:23], v[22:23], v[12:13] op_sel:[0,1] op_sel_hi:[1,1]
    v_pk_mul_f32 v[24:25], v[24:25], v[12:13] op_sel:[0,1] op_sel_hi:[1,1]
    v_pk_mul_f32 v[26:27], v[26:27], v[12:13] op_sel:[0,1] op_sel_hi:[1,1]
    v_pk_mul_f32 v[28:29], v[28:29], v[12:13] op_sel:[0,1] op_sel_hi:[1,1]
    v_pk_mul_f32 v[30:31], v[30:31], v[12:13] op_sel:[0,1] op_sel_hi:[1,1]
    v_cvt_pk_bf16_f32 v16, v16, v17
    v_cvt_pk_bf16_f32 v18, v18, v19
    v_cvt_pk_bf16_f32 v20, v20, v21
    v_cvt_pk_bf16_f32 v22, v22, v23
    v_cvt_pk_bf16_f32 v24, v24, v25
    v_cvt_pk_bf16_f32 v26, v26, v27
    v_cvt_pk_bf16_f32 v28, v28, v29
    v_cvt_pk_bf16_f32 v30, v30, v31
    v_and_b32 v17, s27, v16
    v_lshlrev_b32 v16, 16, v16
    v_and_b32 v19, s27, v18
    v_lshlrev_b32 v18, 16, v18
    v_and_b32 v21, s27, v20
    v_lshlrev_b32 v20, 16, v20
    v_and_b32 v23, s27, v22
    v_lshlrev_b32 v22, 16, v22
    v_and_b32 v25, s27, v24
    v_lshlrev_b32 v24, 16, v24
    v_and_b32 v27, s27, v26
    v_lshlrev_b32 v26, 16, v26
    v_and_b32 v29, s27, v28
    v_lshlrev_b32 v28, 16, v28
    v_and_b32 v31, s27, v30
    v_lshlrev_b32 v30, 16, v30
    v_pk_add_f32 v[16:17], v[16:17], v[148:149]
    v_pk_add_f32 v[18:19], v[18:19], v[150:151]
    v_pk_add_f32 v[20:21], v[20:21], v[152:153]
    v_pk_add_f32 v[22:23], v[22:23], v[154:155]
    v_pk_add_f32 v[24:25], v[24:25], v[156:157]
    v_pk_add_f32 v[26:27], v[26:27], v[158:159]
    v_pk_add_f32 v[28:29], v[28:29], v[160:161]
    v_pk_add_f32 v[30:31], v[30:31], v[162:163]
    v_cvt_pk_bf16_f32 v32, v16, v17
    v_cvt_pk_bf16_f32 v33, v18, v19
    v_cvt_pk_bf16_f32 v34, v20, v21
    v_cvt_pk_bf16_f32 v35, v22, v23
    v_cvt_pk_bf16_f32 v36, v24, v25
    v_cvt_pk_bf16_f32 v37, v26, v27
    v_cvt_pk_bf16_f32 v38, v28, v29
    v_cvt_pk_bf16_f32 v39, v30, v31
    s_nop 1
    v_permlane32_swap_b32 v32, v34
    v_permlane32_swap_b32 v33, v35
    v_permlane32_swap_b32 v36, v38
    v_permlane32_swap_b32 v37, v39
    buffer_store_dwordx4 v[32:35], v15, s[20:23], s28 offen
    buffer_store_dwordx4 v[36:39], v15, s[20:23], s28 offen offset:32
    s_endpgm
F_KGEN:
K_NF:
    s_mov_b32 s70, 0x3fb8aa3b
    s_mov_b32 s71, 0x32a57060
    s_mov_b32 s72, 0x3f317218
    s_mov_b32 s73, 0xffff0000
    s_mov_b32 s60, 0x01000100
    s_mov_b32 s61, 0x03020302
    s_mov_b32 s62, 0x01000302
    s_mul_i32 s5, s8, 8832
    s_add_u32 s5, s5, s29
    s_sub_u32 s63, s2, 96
    s_cmp_lt_u32 s63, 128
    s_cselect_b32 s63, s3, 0
    s_bfe_u32 s21, s2, 0x10002
    v_lshrrev_b32 v6, 4, v0
    v_bfe_u32 v7, v0, 2, 2
    v_lshl_add_u32 v130, v6, 3, v7
    v_bfe_u32 v131, v0, 1, 1
    s_lshl_b32 s22, s21, 2
    v_add_u32 v131, s22, v131
    v_bfe_u32 v7, v130, 1, 3
    v_xor_b32 v131, v131, v7
    v_and_b32 v7, 1, v0
    v_lshlrev_b32 v7, 3, v7
    v_lshl_add_u32 v7, v130, 7, v7
    s_and_b32 s22, s3, 3
    s_lshl_b32 s23, s22, 12
    s_add_u32 s23, s23, 16384
    v_add_u32 v7, s23, v7
    s_mul_i32 s66, s22, 36864
    v_lshl_add_u32 v130, v131, 4, v7
    v_xor_b32 v131, 32, v130
    v_mul_u32_u24 v129, 9216, v6
    v_and_b32 v7, 15, v0
    v_lshl_add_u32 v129, v7, 4, v129
    s_and_b32 s23, s2, 3
    s_lshl_b32 s23, s23, 2
    s_bfe_u32 s22, s2, 0x20003
    s_add_u32 s23, s23, s22
    s_lshl_b32 s22, s20, 1
    s_add_u32 s22, s22, s21
    s_mul_i32 s64, s23, 147456
    s_lshl_b32 s21, s22, 9
    s_add_u32 s64, s64, s21
    s_add_u32 s64, s64, s66
    s_add_u32 s64, s64, 10100736
    s_lshl_b32 s65, s22, 4
    s_add_u32 s65, s65, s23
    s_lshl_b32 s65, s65, 7
    s_add_u32 s65, s65, 14839808
    s_mul_i32 s6, s9, 4416
    s_add_u32 s6, s6, s5
    v_lshl_add_u32 v108, v0, 2, s6
    v_add_u32 v109, 1088, v108
    v_add_u32 v110, 2176, v108
    v_add_u32 v111, 3264, v108
    v_and_b32 v18, 15, v0
    v_lshrrev_b32 v19, 4, v0
    v_mul_u32_u24 v112, 272, v18
    v_lshl_add_u32 v112, v19, 4, v112
    v_add_u32 v112, s6, v112
    v_lshrrev_b32 v20, 1, v19
    v_lshlrev_b32 v20, 8, v20
    v_and_b32 v21, 1, v19
    v_lshl_add_u32 v20, v21, 3, v20
    v_lshl_add_u32 v20, v18, 4, v20
    v_add_u32 v113, s5, v20
    v_cmp_gt_u32 vcc, 2, v19
    v_lshlrev_b32 v21, 2, v18
    v_lshlrev_b32 v22, 3, v18
    v_cndmask_b32 v21, v21, v22, vcc
    v_lshl_add_u32 v21, v19, 7, v21
    v_add_u32 v114, s5, v21
    v_mov_b32 v22, 64
    v_mov_b32 v23, 4
    v_cndmask_b32 v22, v22, v23, vcc
    v_add_u32 v115, v22, v114
    v_lshlrev_b32 v23, 7, v19
    v_lshl_add_u32 v23, v18, 1, v23
    v_add_u32 v116, s5, v23
    v_lshl_add_u32 v117, v0, 1, s5
    v_lshlrev_b32 v20, 4, v4
    v_cmp_eq_u32 vcc, 1, v5
    v_lshlrev_b32 v21, 3, v4
    v_add_u32 v21, 508, v21
    v_cndmask_b32 v20, v20, v21, vcc
    v_add_u32 v118, s5, v20
    v_mov_b32 v119, 0x05040706
    v_mov_b32 v20, 0x03020504
    v_cndmask_b32 v119, v119, v20, vcc
    v_mov_b32 v120, 0x01000302
    v_mov_b32 v20, 0x01000100
    v_cndmask_b32 v120, v120, v20, vcc
    v_mov_b32 v121, 0x01000302
    v_mov_b32 v20, 0x03020504
    v_cndmask_b32 v121, v121, v20, vcc
    v_mov_b32 v122, 0x01000302
    v_mov_b32 v20, 0x05040504
    v_cndmask_b32 v122, v122, v20, vcc
    v_and_b32 v20, 1, v0
    v_cmp_eq_u32 vcc, 1, v20
    v_lshlrev_b32 v22, 4, v0
    v_sub_u32 v21, 1008, v22
    v_mov_b32 v123, 0x01000302
    v_mov_b32 v20, 0x03020302
    v_cndmask_b32 v123, v123, v20, vcc
    v_add_u32 v124, s5, v21
    v_add_u32 v125, s5, v22
    v_mov_b32 v126, 0
    s_lshl_b32 s6, s8, 2
    v_add_u32 v127, s6, v3
    s_cmp_lg_u32 s30, 1
    s_cbranch_scc1 K_B_27
    s_barrier
K_B_27:
    s_cmp_eq_u32 s63, 0
    s_cbranch_scc1 K_UB1
    ds_read_b64_tr_b16 v[48:49], v130
    ds_read_b64_tr_b16 v[50:51], v131 offset:512
    ds_read_b64_tr_b16 v[52:53], v131
    ds_read_b64_tr_b16 v[54:55], v130 offset:512
    s_waitcnt lgkmcnt(0)
    buffer_store_dwordx4 v[48:51], v129, s[16:19], s64 offen offset:0 sc1
    buffer_store_dwordx4 v[52:55], v129, s[16:19], s64 offen offset:256 sc1
    s_load_dword s74, s[56:57], 0
K_UB1:
    s_cmp_lg_u32 s30, 1
    s_cbranch_scc1 K_NI
    global_load_ushort v8, v15, s[42:43] offset:0
    global_load_ushort v9, v14, s[34:35] offset:0
    global_load_ushort v10, v14, s[36:37] offset:0
    global_load_ushort v11, v14, s[38:39] offset:0
    global_load_ushort v12, v14, s[40:41] offset:0
    global_load_ushort v157, v15, s[44:45] offset:0
K_NI:
    s_cmp_lg_u32 s30, 1
    s_cbranch_scc1 K_B_28
    s_barrier
K_B_28:
    s_cmp_lg_u32 s30, 1
    s_cbranch_scc1 K_B_29
    s_barrier
K_B_29:
    s_cmp_lg_u32 s30, 1
    s_cbranch_scc1 K_B_30
    s_barrier
K_B_30:
    s_waitcnt vmcnt(0) lgkmcnt(0)
    v_lshlrev_b32 v8, 16, v8
    v_lshlrev_b32 v6, 16, v9
    v_mul_f32 v34, s70, v8
    v_fma_f32 v35, v8, s70, -v34
    v_fma_f32 v35, v8, s71, v35
    v_exp_f32 v34, v34
    v_mul_f32 v35, s72, v35
    v_fma_f32 v8, v34, v35, v34
    v_mul_f32 v32, s70, v6
    v_fma_f32 v33, v6, s70, -v32
    v_fma_f32 v33, v6, s71, v33
    v_exp_f32 v32, v32
    v_mul_f32 v33, s72, v33
    v_fma_f32 v6, v32, v33, v32
    v_lshlrev_b32 v7, 16, v10
    v_cvt_pk_bf16_f32 v8, v8, v8
    v_cvt_pk_bf16_f32 v6, v6, v6
    v_lshlrev_b32 v14, 16, v11
    v_and_b32 v8, s73, v8
    v_and_b32 v6, s73, v6
    v_lshlrev_b32 v15, 16, v12
    v_mul_f32 v7, v7, v8
    v_mul_f32 v6, v6, v8
    v_mul_f32 v14, v14, v8
    v_mul_f32 v15, v15, v8
    v_mul_f32 v7, 0.15915494, v7
    v_mul_f32 v6, s70, v6
    v_add_f32 v14, v14, v14
    v_add_f32 v15, v15, v15
    v_mov_b32 v48, 0x3f80
    v_mul_f32 v19, 0x3f800000, v7
    v_mul_f32 v23, 0xc1000000, v7
    v_mul_f32 v27, 0x43000000, v7
    v_mul_f32 v18, 0xbf800000, v6
    v_mul_f32 v22, 0xc1000000, v6
    v_mul_f32 v26, 0xc3000000, v6
    v_fract_f32 v19, v19
    v_fract_f32 v23, v23
    v_fract_f32 v27, v27
    v_exp_f32 v18, v18
    v_exp_f32 v22, v22
    v_exp_f32 v26, v26
    v_cos_f32 v20, v19
    v_sin_f32 v21, v19
    v_cos_f32 v24, v23
    v_sin_f32 v25, v23
    v_cos_f32 v28, v27
    v_sin_f32 v29, v27
    s_nop 0
    v_mul_f32 v40, v18, v20
    v_mul_f32 v41, v18, v21
    v_mul_f32 v16, v22, v24
    v_mul_f32 v17, v22, v25
    v_mul_f32 v44, v26, v28
    v_mul_f32 v45, v26, v29
    v_mul_f32 v18, v16, v16
    v_mul_f32 v19, v16, v17
    v_mul_f32 v42, v40, v40
    v_mul_f32 v43, v40, v41
    v_mul_f32 v46, v44, v44
    v_mul_f32 v47, v44, v45
    v_fma_f32 v18, -v17, v17, v18
    v_fmac_f32 v19, v17, v16
    v_fma_f32 v42, -v41, v41, v42
    v_fmac_f32 v43, v41, v40
    v_fma_f32 v46, -v45, v45, v46
    v_fmac_f32 v47, v45, v44
    v_mul_f32 v22, v18, v18
    v_mul_f32 v23, v18, v19
    v_mul_f32 v20, v18, v16
    v_mul_f32 v21, v18, v17
    v_fma_f32 v22, -v19, v19, v22
    v_fmac_f32 v23, v19, v18
    v_fma_f32 v20, -v19, v17, v20
    v_fmac_f32 v21, v19, v16
    v_cvt_pk_bf16_f32 v49, v16, v17
    v_cvt_pk_bf16_f32 v50, v18, v19
    v_mul_f32 v30, v22, v22
    v_mul_f32 v31, v22, v23
    v_mul_f32 v24, v22, v16
    v_mul_f32 v25, v22, v17
    v_mul_f32 v26, v22, v18
    v_mul_f32 v27, v22, v19
    v_mul_f32 v28, v22, v20
    v_mul_f32 v29, v22, v21
    v_fma_f32 v30, -v23, v23, v30
    v_fmac_f32 v31, v23, v22
    v_fma_f32 v24, -v23, v17, v24
    v_fmac_f32 v25, v23, v16
    v_fma_f32 v26, -v23, v19, v26
    v_fmac_f32 v27, v23, v18
    v_fma_f32 v28, -v23, v21, v28
    v_fmac_f32 v29, v23, v20
    v_cvt_pk_bf16_f32 v51, v20, v21
    v_cvt_pk_bf16_f32 v52, v22, v23
    v_cvt_pk_bf16_f32 v53, v24, v25
    v_cvt_pk_bf16_f32 v54, v26, v27
    v_cvt_pk_bf16_f32 v55, v28, v29
    v_cvt_pk_bf16_f32 v56, v30, v31
    v_mul_f32 v32, v16, v30
    v_mul_f32 v33, v16, v31
    v_mul_f32 v34, v18, v30
    v_mul_f32 v35, v18, v31
    v_mul_f32 v36, v20, v30
    v_mul_f32 v37, v20, v31
    v_mul_f32 v38, v22, v30
    v_mul_f32 v39, v22, v31
    v_fma_f32 v16, -v17, v31, v32
    v_fma_f32 v17, v17, v30, v33
    v_fma_f32 v18, -v19, v31, v34
    v_fma_f32 v19, v19, v30, v35
    v_fma_f32 v20, -v21, v31, v36
    v_fma_f32 v21, v21, v30, v37
    v_fma_f32 v22, -v23, v31, v38
    v_fma_f32 v23, v23, v30, v39
    v_mul_f32 v32, v24, v30
    v_mul_f32 v33, v24, v31
    v_mul_f32 v34, v26, v30
    v_mul_f32 v35, v26, v31
    v_mul_f32 v36, v28, v30
    v_mul_f32 v37, v28, v31
    v_fma_f32 v24, -v25, v31, v32
    v_fma_f32 v25, v25, v30, v33
    v_fma_f32 v26, -v27, v31, v34
    v_fma_f32 v27, v27, v30, v35
    v_fma_f32 v28, -v29, v31, v36
    v_fma_f32 v29, v29, v30, v37
    v_cvt_pk_bf16_f32 v57, v16, v17
    v_cvt_pk_bf16_f32 v58, v18, v19
    v_cvt_pk_bf16_f32 v59, v20, v21
    v_cvt_pk_bf16_f32 v60, v22, v23
    v_cvt_pk_bf16_f32 v61, v24, v25
    v_cvt_pk_bf16_f32 v62, v26, v27
    v_cvt_pk_bf16_f32 v63, v28, v29
    v_mov_b32 v16, v14
    v_mov_b32 v17, v15
    v_mul_f32 v18, v14, v40
    v_mul_f32 v19, v14, v41
    v_mul_f32 v20, v14, v42
    v_mul_f32 v21, v14, v43
    v_mul_f32 v32, v42, v42
    v_mul_f32 v33, v42, v43
    v_fma_f32 v18, -v15, v41, v18
    v_fmac_f32 v19, v15, v40
    v_fma_f32 v20, -v15, v43, v20
    v_fmac_f32 v21, v15, v42
    v_fma_f32 v32, -v43, v43, v32
    v_fmac_f32 v33, v43, v42
    v_mul_f32 v22, v18, v42
    s_cmp_lg_u32 s30, 1
    s_cbranch_scc1 K_B_31
    s_barrier
K_B_31:
    s_cmp_eq_u32 s63, 11
    s_cbranch_scc1 K_U5
K_UB5:
    v_mul_f32 v23, v18, v43
    v_mul_f32 v24, v14, v32
    v_mul_f32 v25, v14, v33
    v_mul_f32 v26, v18, v32
    v_mul_f32 v27, v18, v33
    v_mul_f32 v28, v20, v32
    v_mul_f32 v29, v20, v33
    v_fma_f32 v22, -v19, v43, v22
    v_fmac_f32 v23, v19, v42
    v_fma_f32 v24, -v15, v33, v24
    v_fmac_f32 v25, v15, v32
    v_fma_f32 v26, -v19, v33, v26
    v_fmac_f32 v27, v19, v32
    v_fma_f32 v28, -v21, v33, v28
    v_fmac_f32 v29, v21, v32
    v_mul_f32 v30, v22, v32
    v_mul_f32 v31, v22, v33
    v_fma_f32 v30, -v23, v33, v30
    v_fmac_f32 v31, v23, v32
    v_cvt_pk_bf16_f32 v64, v16, v17
    v_cvt_pk_bf16_f32 v65, v18, v19
    v_cvt_pk_bf16_f32 v66, v20, v21
    v_cvt_pk_bf16_f32 v67, v22, v23
    v_cvt_pk_bf16_f32 v68, v24, v25
    v_cvt_pk_bf16_f32 v69, v26, v27
    v_cvt_pk_bf16_f32 v70, v28, v29
    v_cvt_pk_bf16_f32 v71, v30, v31
    v_mul_f32 v32, v16, v44
    v_mul_f32 v33, v16, v45
    v_mul_f32 v34, v20, v44
    v_mul_f32 v35, v20, v45
    v_mul_f32 v36, v24, v44
    v_mul_f32 v37, v24, v45
    v_mul_f32 v38, v28, v44
    v_mul_f32 v39, v28, v45
    v_fma_f32 v16, -v17, v45, v32
    v_fma_f32 v17, v17, v44, v33
    v_fma_f32 v20, -v21, v45, v34
    v_fma_f32 v21, v21, v44, v35
    v_fma_f32 v24, -v25, v45, v36
    v_fma_f32 v25, v25, v44, v37
    v_fma_f32 v28, -v29, v45, v38
    v_fma_f32 v29, v29, v44, v39
    v_mul_f32 v32, v18, v44
    v_mul_f32 v33, v18, v45
    v_mul_f32 v34, v22, v44
    v_mul_f32 v35, v22, v45
    v_mul_f32 v36, v26, v44
    v_mul_f32 v37, v26, v45
    v_mul_f32 v38, v30, v44
    v_mul_f32 v39, v30, v45
    v_fma_f32 v18, -v19, v45, v32
    v_fma_f32 v19, v19, v44, v33
    v_fma_f32 v22, -v23, v45, v34
    v_fma_f32 v23, v23, v44, v35
    v_fma_f32 v26, -v27, v45, v36
    v_fma_f32 v27, v27, v44, v37
    v_fma_f32 v30, -v31, v45, v38
    v_fma_f32 v31, v31, v44, v39
    v_cvt_pk_bf16_f32 v72, v16, v17
    s_cmp_lg_u32 s30, 1
    s_cbranch_scc1 K_B_32
    s_barrier
K_B_32:
    v_cvt_pk_bf16_f32 v73, v18, v19
    v_cvt_pk_bf16_f32 v74, v20, v21
    v_cvt_pk_bf16_f32 v75, v22, v23
    v_cvt_pk_bf16_f32 v76, v24, v25
    v_cvt_pk_bf16_f32 v77, v26, v27
    v_cvt_pk_bf16_f32 v78, v28, v29
    v_cvt_pk_bf16_f32 v79, v30, v31
    v_mul_f32 v32, v16, v44
    v_mul_f32 v33, v16, v45
    v_mul_f32 v34, v20, v44
    v_mul_f32 v35, v20, v45
    v_mul_f32 v36, v24, v44
    v_mul_f32 v37, v24, v45
    v_mul_f32 v38, v28, v44
    v_mul_f32 v39, v28, v45
    v_fma_f32 v16, -v17, v45, v32
    v_fma_f32 v17, v17, v44, v33
    v_fma_f32 v20, -v21, v45, v34
    v_fma_f32 v21, v21, v44, v35
    v_fma_f32 v24, -v25, v45, v36
    v_fma_f32 v25, v25, v44, v37
    v_fma_f32 v28, -v29, v45, v38
    v_fma_f32 v29, v29, v44, v39
    v_mul_f32 v18, v16, v44
    v_mul_f32 v19, v16, v45
    v_mul_f32 v22, v20, v44
    v_mul_f32 v23, v20, v45
    v_mul_f32 v26, v24, v44
    v_mul_f32 v27, v24, v45
    v_mul_f32 v30, v28, v44
    v_mul_f32 v31, v28, v45
    v_fma_f32 v18, -v17, v45, v18
    v_fmac_f32 v19, v17, v44
    v_fma_f32 v22, -v21, v45, v22
    v_fmac_f32 v23, v21, v44
    v_fma_f32 v26, -v25, v45, v26
    v_fmac_f32 v27, v25, v44
    v_fma_f32 v30, -v29, v45, v30
    v_fmac_f32 v31, v29, v44
    v_cvt_pk_bf16_f32 v80, v16, v17
    v_cvt_pk_bf16_f32 v81, v20, v21
    v_cvt_pk_bf16_f32 v82, v24, v25
    v_cvt_pk_bf16_f32 v83, v28, v29
    v_cvt_pk_bf16_f32 v84, v18, v19
    v_cvt_pk_bf16_f32 v85, v22, v23
    v_cvt_pk_bf16_f32 v86, v26, v27
    v_cvt_pk_bf16_f32 v87, v30, v31
    v_mul_f32 v32, v16, v46
    v_mul_f32 v33, v16, v47
    v_mul_f32 v34, v24, v46
    v_mul_f32 v35, v24, v47
    v_mul_f32 v36, v18, v46
    v_mul_f32 v37, v18, v47
    v_mul_f32 v38, v26, v46
    v_mul_f32 v39, v26, v47
    v_fma_f32 v16, -v17, v47, v32
    v_fma_f32 v17, v17, v46, v33
    v_fma_f32 v24, -v25, v47, v34
    v_fma_f32 v25, v25, v46, v35
    v_fma_f32 v18, -v19, v47, v36
    s_cmp_lg_u32 s30, 1
    s_cbranch_scc1 K_B_33
    s_barrier
K_B_33:
    v_fma_f32 v19, v19, v46, v37
    v_fma_f32 v26, -v27, v47, v38
    v_fma_f32 v27, v27, v46, v39
    v_cvt_pk_bf16_f32 v88, v16, v17
    v_cvt_pk_bf16_f32 v89, v24, v25
    v_cvt_pk_bf16_f32 v90, v18, v19
    v_cvt_pk_bf16_f32 v91, v26, v27
    v_mul_f32 v32, v16, v46
    v_mul_f32 v33, v16, v47
    v_mul_f32 v34, v24, v46
    v_mul_f32 v35, v24, v47
    v_mul_f32 v36, v18, v46
    v_mul_f32 v37, v18, v47
    v_mul_f32 v38, v26, v46
    v_mul_f32 v39, v26, v47
    v_fma_f32 v16, -v17, v47, v32
    v_fma_f32 v17, v17, v46, v33
    v_fma_f32 v24, -v25, v47, v34
    v_fma_f32 v25, v25, v46, v35
    v_fma_f32 v18, -v19, v47, v36
    v_fma_f32 v19, v19, v46, v37
    v_fma_f32 v26, -v27, v47, v38
    v_fma_f32 v27, v27, v46, v39
    v_cvt_pk_bf16_f32 v92, v16, v17
    v_cvt_pk_bf16_f32 v93, v24, v25
    v_cvt_pk_bf16_f32 v94, v18, v19
    v_cvt_pk_bf16_f32 v95, v26, v27
    v_mul_f32 v32, v16, v46
    v_mul_f32 v33, v16, v47
    v_mul_f32 v34, v18, v46
    v_mul_f32 v35, v18, v47
    v_fma_f32 v16, -v17, v47, v32
    v_fma_f32 v17, v17, v46, v33
    v_fma_f32 v18, -v19, v47, v34
    v_fma_f32 v19, v19, v46, v35
    v_cvt_pk_bf16_f32 v96, v16, v17
    v_cvt_pk_bf16_f32 v97, v18, v19
    v_mul_f32 v32, v16, v46
    v_mul_f32 v33, v16, v47
    v_mul_f32 v34, v18, v46
    v_mul_f32 v35, v18, v47
    v_fma_f32 v16, -v17, v47, v32
    v_fma_f32 v17, v17, v46, v33
    v_fma_f32 v18, -v19, v47, v34
    v_fma_f32 v19, v19, v46, v35
    v_cvt_pk_bf16_f32 v98, v16, v17
    v_cvt_pk_bf16_f32 v99, v18, v19
    v_mul_f32 v32, v16, v46
    v_mul_f32 v33, v16, v47
    v_mul_f32 v34, v18, v46
    v_mul_f32 v35, v18, v47
    v_fma_f32 v16, -v17, v47, v32
    v_fma_f32 v17, v17, v46, v33
    v_fma_f32 v18, -v19, v47, v34
    v_fma_f32 v19, v19, v46, v35
    v_cvt_pk_bf16_f32 v100, v16, v17
    v_cvt_pk_bf16_f32 v101, v18, v19
    v_mul_f32 v32, v16, v46
    v_mul_f32 v33, v16, v47
    v_mul_f32 v34, v18, v46
    s_cmp_lg_u32 s30, 1
    s_cbranch_scc1 K_B_34
    s_barrier
K_B_34:
    v_mul_f32 v35, v18, v47
    v_fma_f32 v16, -v17, v47, v32
    v_fma_f32 v17, v17, v46, v33
    v_fma_f32 v18, -v19, v47, v34
    v_fma_f32 v19, v19, v46, v35
    v_cvt_pk_bf16_f32 v102, v16, v17
    v_cvt_pk_bf16_f32 v103, v18, v19
    v_mul_f32 v32, v16, v46
    v_mul_f32 v33, v16, v47
    v_fma_f32 v16, -v17, v47, v32
    v_fma_f32 v17, v17, v46, v33
    v_cvt_pk_bf16_f32 v104, v16, v17
    v_and_b32 v10, 15, v0
    v_lshrrev_b32 v11, 4, v0
    v_sub_u32 v6, 15, v10
    v_lshl_add_u32 v6, v11, 3, v6
    v_and_b32 v7, 1, v6
    v_mul_u32_u24 v7, 4414, v7
    v_lshl_add_u32 v6, v6, 1, v7
    s_lshl_b32 s66, s9, 8
    s_add_u32 s66, s66, s5
    v_add_u32 v6, s66, v6
    v_add_u32 v7, 1024, v6
    v_add_u32 v8, 2048, v6
    v_add_u32 v9, 3072, v6
    v_lshl_add_u32 v4, v10, 1, v11
    s_lshl_b32 s66, s9, 4
    s_add_u32 s66, s66, 2
    v_add_u32 v4, s66, v4
    s_lshr_b32 s66, s8, 1
    s_mul_i32 s66, s66, 18432
    s_lshl_b32 s15, s8, 14
    s_add_u32 s15, s15, s66
    s_lshl_b32 s66, s9, 13
    s_add_u32 s66, s66, s15
    v_lshrrev_b32 v5, 2, v0
    v_and_b32 v5, 8, v5
    v_xor_b32 v5, v5, v0
    v_lshl_add_u32 v5, v5, 4, s66
    v_bfe_u32 v10, v4, 2, 2
    v_xor_b32 v10, s8, v10
    v_lshlrev_b32 v10, 4, v10
    v_lshl_add_u32 v10, v4, 6, v10
    v_add_u32 v10, 32768, v10
    v_add_u32 v4, 4, v4
    v_bfe_u32 v11, v4, 2, 2
    v_xor_b32 v11, s8, v11
    v_lshlrev_b32 v11, 4, v11
    v_lshl_add_u32 v11, v4, 6, v11
    v_add_u32 v11, 32768, v11
    s_mul_i32 s66, s9, 1179648
    s_lshl_b32 s24, s31, 7
    s_add_u32 s25, s24, 14917632
    s_add_u32 s24, s24, s66
    s_lshl_b32 s66, s8, 6
    s_add_u32 s24, s24, s66
    s_add_u32 s24, s24, 12460032
    v_lshlrev_b32 v12, 16, v157
    s_nop 0
    v_readfirstlane_b32 s20, v12
    s_cmp_lg_u32 s30, 1
    s_cbranch_scc1 K_B_35
    s_barrier
K_B_35:
    ds_write2_b32 v108, v48, v49 offset0:0 offset1:68
    ds_write2_b32 v108, v50, v51 offset0:136 offset1:204
    ds_write2_b32 v109, v52, v53 offset0:0 offset1:68
    ds_write2_b32 v109, v54, v55 offset0:136 offset1:204
    ds_write2_b32 v110, v56, v57 offset0:0 offset1:68
    ds_write2_b32 v110, v58, v59 offset0:136 offset1:204
    ds_write2_b32 v111, v60, v61 offset0:0 offset1:68
    ds_write2_b32 v111, v62, v63 offset0:136 offset1:204
    ds_read_b128 v[48:51], v112 offset:0
    ds_read_b128 v[52:55], v112 offset:64
    ds_read_b128 v[56:59], v112 offset:128
    ds_read_b128 v[60:63], v112 offset:192
    ds_write2_b32 v108, v64, v65 offset0:0 offset1:68
    ds_write2_b32 v108, v66, v67 offset0:136 offset1:204
    ds_write2_b32 v109, v68, v69 offset0:0 offset1:68
    ds_write2_b32 v109, v70, v71 offset0:136 offset1:204
    ds_write2_b32 v110, v72, v73 offset0:0 offset1:68
    ds_write2_b32 v110, v74, v75 offset0:136 offset1:204
    ds_write2_b32 v111, v76, v77 offset0:0 offset1:68
    ds_write2_b32 v111, v78, v79 offset0:136 offset1:204
    ds_read_b128 v[64:67], v112 offset:0
    ds_read_b128 v[68:71], v112 offset:64
    ds_read_b128 v[72:75], v112 offset:128
    ds_read_b128 v[76:79], v112 offset:192
    ds_write2_b32 v108, v80, v81 offset0:0 offset1:68
    ds_write2_b32 v108, v82, v83 offset0:136 offset1:204
    ds_write2_b32 v109, v84, v85 offset0:0 offset1:68
    ds_write2_b32 v109, v86, v87 offset0:136 offset1:204
    ds_write2_b32 v110, v88, v89 offset0:0 offset1:68
    ds_write2_b32 v110, v90, v91 offset0:136 offset1:204
    ds_write2_b32 v111, v92, v93 offset0:0 offset1:68
    ds_write2_b32 v111, v94, v95 offset0:136 offset1:204
    ds_read_b128 v[80:83], v112 offset:0
    ds_read_b128 v[84:87], v112 offset:64
    ds_read_b128 v[88:91], v112 offset:128
    ds_read_b128 v[92:95], v112 offset:192
    ds_write2_b32 v108, v96, v97 offset0:0 offset1:68
    ds_write2_b32 v108, v98, v99 offset0:136 offset1:204
    ds_write2_b32 v109, v100, v101 offset0:0 offset1:68
    ds_write2_b32 v109, v102, v103 offset0:136 offset1:204
    ds_write2_b32 v110, v104, v105 offset0:0 offset1:68
    ds_read_b128 v[16:19], v112 offset:0
    ds_read_b128 v[20:23], v112 offset:64
    ds_read_b128 v[24:27], v112 offset:128
    ds_read_b128 v[28:31], v112 offset:192
    s_waitcnt lgkmcnt(15)
    v_mfma_f32_16x16x32_bf16 v[132:135], v[64:67], v[48:51], 0
    v_mfma_f32_16x16x32_bf16 v[132:135], v[68:71], v[52:55], v[132:135]
    v_mfma_f32_16x16x32_bf16 v[132:135], v[72:75], v[56:59], v[132:135]
    v_mfma_f32_16x16x32_bf16 v[132:135], v[76:79], v[60:63], v[132:135]
    s_waitcnt lgkmcnt(9)
    v_mfma_f32_16x16x32_bf16 v[136:139], v[80:83], v[48:51], 0
    v_mfma_f32_16x16x32_bf16 v[136:139], v[84:87], v[52:55], v[136:139]
    v_mfma_f32_16x16x32_bf16 v[136:139], v[88:91], v[56:59], v[136:139]
    v_mfma_f32_16x16x32_bf16 v[136:139], v[92:95], v[60:63], v[136:139]
    s_waitcnt lgkmcnt(0)
    v_mfma_f32_16x16x32_bf16 v[140:143], v[16:19], v[48:51], 0
    v_mfma_f32_16x16x32_bf16 v[140:143], v[20:23], v[52:55], v[140:143]
    v_mfma_f32_16x16x32_bf16 v[140:143], v[24:27], v[56:59], v[140:143]
    v_mfma_f32_16x16x32_bf16 v[140:143], v[28:31], v[60:63], v[140:143]
    s_cmp_eq_u32 s9, 0
    s_cbranch_scc1 K_LEAD
    s_nop 5
    ds_write_b128 v125, v[132:135] offset:4416
    ds_write_b128 v125, v[136:139] offset:5440
    ds_write_b128 v125, v[140:143] offset:6464
    s_waitcnt lgkmcnt(0)
    s_mov_b64 exec, 1
    ds_add_u32 v127, v1 offset:48
    s_mov_b64 exec, -1
    s_branch K_NEXT
K_LEAD:
    s_mov_b32 s97, 4194304
K_PW:
    ds_read_b32 v2, v127 offset:48
    s_waitcnt lgkmcnt(0)
    v_readfirstlane_b32 s96, v2
    s_cmp_ge_u32 s96, 1
    s_cbranch_scc1 K_PWOK
    s_sub_u32 s97, s97, 1
    s_cbranch_scc0 K_PW
K_PWOK:
    ds_read_b128 v[72:75], v125 offset:4416
    ds_read_b128 v[76:79], v125 offset:5440
    ds_read_b128 v[80:83], v125 offset:6464
    s_waitcnt lgkmcnt(0)
    v_pk_add_f32 v[132:133], v[132:133], v[72:73]
    v_pk_add_f32 v[134:135], v[134:135], v[74:75]
    v_pk_add_f32 v[136:137], v[136:137], v[76:77]
    v_pk_add_f32 v[138:139], v[138:139], v[78:79]
    v_pk_add_f32 v[140:141], v[140:141], v[80:81]
    v_pk_add_f32 v[142:143], v[142:143], v[82:83]
    v_cvt_pk_bf16_f32 v24, v132, v133
    v_cvt_pk_bf16_f32 v25, v134, v135
    v_cvt_pk_bf16_f32 v26, v136, v137
    v_cvt_pk_bf16_f32 v27, v138, v139
    v_cvt_pk_bf16_f32 v28, v140, v141
    v_cvt_pk_bf16_f32 v29, v142, v143
    ds_write_b64 v113, v[24:25]
    ds_write_b32 v114, v26 offset:512
    ds_write_b32 v115, v27 offset:512
    ds_write_b16 v116, v28 offset:1024
    ds_write_b16_d16_hi v116, v28 offset:1056
    ds_write_b16 v116, v29 offset:1088
    ds_write_b16_d16_hi v116, v29 offset:1120
    ds_read_u16 v30, v117 offset:1024
    ds_read_u16 v31, v117 offset:1152
    ds_read_u16 v34, v117 offset:1026
    ds_read_u16 v35, v117 offset:1154
    ds_read2_b32 v[32:33], v108 offset0:192 offset1:193
    ds_read2_b32 v[36:37], v118 offset0:0 offset1:1
    ds_read2_b32 v[38:39], v118 offset0:2 offset1:3
    s_waitcnt lgkmcnt(0)
    v_lshl_or_b32 v30, v34, 16, v30
    v_lshl_or_b32 v31, v35, 16, v31
    v_perm_b32 v64, v33, v33, s60
    v_perm_b32 v65, v32, v32, s61
    v_perm_b32 v66, v32, v32, s62
    v_perm_b32 v67, v32, v32, s60
    v_perm_b32 v68, v39, v38, v119
    v_perm_b32 v69, v38, v38, v120
    v_perm_b32 v70, v38, v37, v121
    v_perm_b32 v71, v37, v36, v122
    ds_write_b128 v124, v[64:67] offset:2048
    ds_write_b128 v124, v[68:71] offset:3072
    v_perm_b32 v56, v30, v30, s61
    v_perm_b32 v57, v30, v30, v123
    v_perm_b32 v58, v30, v30, s60
    v_perm_b32 v59, v30, v30, s60
    v_perm_b32 v60, v31, v31, s61
    v_perm_b32 v61, v31, v31, v123
    v_perm_b32 v62, v31, v31, s60
    v_perm_b32 v63, v31, v31, s60
    ds_write_b128 v124, v[56:59] offset:1024
    ds_write_b128 v124, v[60:63]
    s_mov_b64 exec, 0xffff
    ds_write_b32 v108, v126 offset:4096
    ds_write_b32 v108, v126 offset:8512
    s_mov_b64 exec, -1
    ds_read_b128 v[72:75], v125 offset:0
    ds_read_b32 v76, v125 offset:16
    ds_read_b128 v[80:83], v125 offset:1024
    ds_read_b32 v84, v125 offset:1040
    ds_read_b128 v[88:91], v125 offset:2048
    ds_read_b32 v92, v125 offset:2064
    ds_read_b128 v[96:99], v125 offset:3072
    ds_read_b32 v100, v125 offset:3088
    s_waitcnt lgkmcnt(6)
    v_alignbit_b32 v72, v73, v72, 16
    v_alignbit_b32 v73, v74, v73, 16
    v_alignbit_b32 v74, v75, v74, 16
    v_alignbit_b32 v75, v76, v75, 16
    ds_write_b128 v125, v[72:75] offset:4416
    s_waitcnt lgkmcnt(5)
    v_alignbit_b32 v80, v81, v80, 16
    v_alignbit_b32 v81, v82, v81, 16
    v_alignbit_b32 v82, v83, v82, 16
    v_alignbit_b32 v83, v84, v83, 16
    ds_write_b128 v125, v[80:83] offset:5440
    s_waitcnt lgkmcnt(4)
    v_alignbit_b32 v88, v89, v88, 16
    v_alignbit_b32 v89, v90, v89, 16
    v_alignbit_b32 v90, v91, v90, 16
    v_alignbit_b32 v91, v92, v91, 16
    ds_write_b128 v125, v[88:91] offset:6464
    s_waitcnt lgkmcnt(3)
    v_alignbit_b32 v96, v97, v96, 16
    v_alignbit_b32 v97, v98, v97, 16
    v_alignbit_b32 v98, v99, v98, 16
    v_alignbit_b32 v99, v100, v99, 16
    ds_write_b128 v125, v[96:99] offset:7488
    s_waitcnt lgkmcnt(0)
    s_mov_b64 exec, 1
    ds_add_u32 v127, v1 offset:64
    s_mov_b64 exec, -1
K_NEXT:
    v_mov_b32 v4, v127
    s_setprio 0
    s_mov_b32 s97, 4194304
C_W:
    ds_read_b64 v[12:13], v3
    ds_read_b32 v14, v4 offset:64
    s_waitcnt lgkmcnt(0)
    v_lshrrev_b32 v13, 2, v13
    v_min3_u32 v12, v12, v13, v14
    s_nop 0
    v_readfirstlane_b32 s96, v12
    s_cmp_ge_u32 s96, 1
    s_cbranch_scc1 C_WOK
    s_sleep 1
    s_sub_u32 s97, s97, 1
    s_cbranch_scc0 C_W
C_WOK:
    s_setprio 3
    ds_read2_b32 v[44:45], v9 offset0:128 offset1:129
    ds_read2_b32 v[46:47], v9 offset0:130 offset1:131
    ds_read_b128 v[76:79], v10 offset:0
    ds_read2_b32 v[48:49], v9 offset0:0 offset1:1
    ds_read2_b32 v[50:51], v9 offset0:2 offset1:3
    ds_read_b128 v[80:83], v10 offset:2048
    ds_read2_b32 v[52:53], v8 offset0:128 offset1:129
    ds_read2_b32 v[54:55], v8 offset0:130 offset1:131
    ds_read_b128 v[84:87], v10 offset:4096
    ds_read2_b32 v[56:57], v8 offset0:0 offset1:1
    ds_read2_b32 v[58:59], v8 offset0:2 offset1:3
    ds_read_b128 v[88:91], v10 offset:6144
    ds_read2_b32 v[60:61], v7 offset0:128 offset1:129
    ds_read2_b32 v[62:63], v7 offset0:130 offset1:131
    ds_read_b128 v[92:95], v10 offset:8192
    ds_read2_b32 v[64:65], v7 offset0:0 offset1:1
    ds_read2_b32 v[66:67], v7 offset0:2 offset1:3
    ds_read_b128 v[96:99], v10 offset:10240
    ds_read2_b32 v[68:69], v6 offset0:128 offset1:129
    ds_read2_b32 v[70:71], v6 offset0:130 offset1:131
    ds_read_b128 v[100:103], v10 offset:12288
    ds_read2_b32 v[72:73], v6 offset0:0 offset1:1
    ds_read2_b32 v[74:75], v6 offset0:2 offset1:3
    ds_read_b128 v[164:167], v10 offset:14336
    s_waitcnt lgkmcnt(0)
    v_mfma_f32_16x16x32_bf16 v[40:43], v[44:47], v[164:167], 0
    v_mfma_f32_16x16x32_bf16 v[12:15], v[44:47], v[76:79], 0
    ds_read2_b32 v[104:105], v9 offset0:144 offset1:145
    v_mfma_f32_16x16x32_bf16 v[16:19], v[44:47], v[80:83], 0
    ds_read2_b32 v[106:107], v9 offset0:146 offset1:147
    v_mfma_f32_16x16x32_bf16 v[20:23], v[44:47], v[84:87], 0
    ds_read_b128 v[136:139], v11 offset:0
    v_mfma_f32_16x16x32_bf16 v[24:27], v[44:47], v[88:91], 0
    ds_read2_b32 v[108:109], v9 offset0:16 offset1:17
    v_mfma_f32_16x16x32_bf16 v[28:31], v[44:47], v[92:95], 0
    ds_read2_b32 v[110:111], v9 offset0:18 offset1:19
    v_mfma_f32_16x16x32_bf16 v[32:35], v[44:47], v[96:99], 0
    ds_read_b128 v[140:143], v11 offset:2048
    v_mfma_f32_16x16x32_bf16 v[36:39], v[44:47], v[100:103], 0
    ds_read2_b32 v[112:113], v8 offset0:144 offset1:145
    v_mfma_f32_16x16x32_bf16 v[16:19], v[48:51], v[76:79], v[16:19]
    ds_read2_b32 v[114:115], v8 offset0:146 offset1:147
    v_mfma_f32_16x16x32_bf16 v[20:23], v[48:51], v[80:83], v[20:23]
    ds_read_b128 v[144:147], v11 offset:4096
    v_mfma_f32_16x16x32_bf16 v[24:27], v[48:51], v[84:87], v[24:27]
    ds_read2_b32 v[116:117], v8 offset0:16 offset1:17
    v_mfma_f32_16x16x32_bf16 v[28:31], v[48:51], v[88:91], v[28:31]
    ds_read2_b32 v[118:119], v8 offset0:18 offset1:19
    v_mfma_f32_16x16x32_bf16 v[32:35], v[48:51], v[92:95], v[32:35]
    ds_read_b128 v[148:151], v11 offset:6144
    v_mfma_f32_16x16x32_bf16 v[36:39], v[48:51], v[96:99], v[36:39]
    ds_read2_b32 v[120:121], v7 offset0:144 offset1:145
    v_mfma_f32_16x16x32_bf16 v[40:43], v[48:51], v[100:103], v[40:43]
    ds_read2_b32 v[122:123], v7 offset0:146 offset1:147
    v_mfma_f32_16x16x32_bf16 v[20:23], v[52:55], v[76:79], v[20:23]
    ds_read_b128 v[152:155], v11 offset:8192
    v_mfma_f32_16x16x32_bf16 v[24:27], v[52:55], v[80:83], v[24:27]
    ds_read2_b32 v[124:125], v7 offset0:16 offset1:17
    v_mfma_f32_16x16x32_bf16 v[28:31], v[52:55], v[84:87], v[28:31]
    ds_read2_b32 v[126:127], v7 offset0:18 offset1:19
    v_mfma_f32_16x16x32_bf16 v[32:35], v[52:55], v[88:91], v[32:35]
    ds_read_b128 v[156:159], v11 offset:10240
    v_mfma_f32_16x16x32_bf16 v[36:39], v[52:55], v[92:95], v[36:39]
    ds_read2_b32 v[128:129], v6 offset0:144 offset1:145
    v_mfma_f32_16x16x32_bf16 v[40:43], v[52:55], v[96:99], v[40:43]
    ds_read2_b32 v[130:131], v6 offset0:146 offset1:147
    v_mfma_f32_16x16x32_bf16 v[24:27], v[56:59], v[76:79], v[24:27]
    ds_read_b128 v[160:163], v11 offset:12288
    v_mfma_f32_16x16x32_bf16 v[28:31], v[56:59], v[80:83], v[28:31]
    ds_read2_b32 v[132:133], v6 offset0:16 offset1:17
    v_mfma_f32_16x16x32_bf16 v[32:35], v[56:59], v[84:87], v[32:35]
    ds_read2_b32 v[134:135], v6 offset0:18 offset1:19
    v_mfma_f32_16x16x32_bf16 v[36:39], v[56:59], v[88:91], v[36:39]
    ds_read_b128 v[164:167], v11 offset:14336
    v_mfma_f32_16x16x32_bf16 v[40:43], v[56:59], v[92:95], v[40:43]
    v_mfma_f32_16x16x32_bf16 v[28:31], v[60:63], v[76:79], v[28:31]
    v_mfma_f32_16x16x32_bf16 v[32:35], v[60:63], v[80:83], v[32:35]
    v_mfma_f32_16x16x32_bf16 v[36:39], v[60:63], v[84:87], v[36:39]
    v_mfma_f32_16x16x32_bf16 v[40:43], v[60:63], v[88:91], v[40:43]
    v_mfma_f32_16x16x32_bf16 v[32:35], v[64:67], v[76:79], v[32:35]
    v_mfma_f32_16x16x32_bf16 v[36:39], v[64:67], v[80:83], v[36:39]
    v_mfma_f32_16x16x32_bf16 v[40:43], v[64:67], v[84:87], v[40:43]
    v_mfma_f32_16x16x32_bf16 v[36:39], v[68:71], v[76:79], v[36:39]
    v_mfma_f32_16x16x32_bf16 v[40:43], v[68:71], v[80:83], v[40:43]
    v_mfma_f32_16x16x32_bf16 v[40:43], v[72:75], v[76:79], v[40:43]
    s_waitcnt lgkmcnt(0)
    v_mfma_f32_16x16x32_bf16 v[40:43], v[104:107], v[164:167], v[40:43]
    v_mfma_f32_16x16x32_bf16 v[12:15], v[104:107], v[136:139], v[12:15]
    v_xor_b32 v10, 32, v10
    v_mfma_f32_16x16x32_bf16 v[16:19], v[104:107], v[140:143], v[16:19]
    ds_read2_b32 v[44:45], v9 offset0:160 offset1:161
    v_mfma_f32_16x16x32_bf16 v[20:23], v[104:107], v[144:147], v[20:23]
    ds_read2_b32 v[46:47], v9 offset0:162 offset1:163
    v_mfma_f32_16x16x32_bf16 v[24:27], v[104:107], v[148:151], v[24:27]
    ds_read_b128 v[76:79], v10 offset:512
    v_mfma_f32_16x16x32_bf16 v[28:31], v[104:107], v[152:155], v[28:31]
    ds_read2_b32 v[48:49], v9 offset0:32 offset1:33
    v_mfma_f32_16x16x32_bf16 v[32:35], v[104:107], v[156:159], v[32:35]
    ds_read2_b32 v[50:51], v9 offset0:34 offset1:35
    v_mfma_f32_16x16x32_bf16 v[36:39], v[104:107], v[160:163], v[36:39]
    ds_read_b128 v[80:83], v10 offset:2560
    v_mfma_f32_16x16x32_bf16 v[16:19], v[108:111], v[136:139], v[16:19]
    ds_read2_b32 v[52:53], v8 offset0:160 offset1:161
    v_mfma_f32_16x16x32_bf16 v[20:23], v[108:111], v[140:143], v[20:23]
    ds_read2_b32 v[54:55], v8 offset0:162 offset1:163
    v_mfma_f32_16x16x32_bf16 v[24:27], v[108:111], v[144:147], v[24:27]
    ds_read_b128 v[84:87], v10 offset:4608
    v_mfma_f32_16x16x32_bf16 v[28:31], v[108:111], v[148:151], v[28:31]
    ds_read2_b32 v[56:57], v8 offset0:32 offset1:33
    v_mfma_f32_16x16x32_bf16 v[32:35], v[108:111], v[152:155], v[32:35]
    ds_read2_b32 v[58:59], v8 offset0:34 offset1:35
    v_mfma_f32_16x16x32_bf16 v[36:39], v[108:111], v[156:159], v[36:39]
    ds_read_b128 v[88:91], v10 offset:6656
    v_mfma_f32_16x16x32_bf16 v[40:43], v[108:111], v[160:163], v[40:43]
    ds_read2_b32 v[60:61], v7 offset0:160 offset1:161
    v_mfma_f32_16x16x32_bf16 v[20:23], v[112:115], v[136:139], v[20:23]
    ds_read2_b32 v[62:63], v7 offset0:162 offset1:163
    v_mfma_f32_16x16x32_bf16 v[24:27], v[112:115], v[140:143], v[24:27]
    ds_read_b128 v[92:95], v10 offset:8704
    v_mfma_f32_16x16x32_bf16 v[28:31], v[112:115], v[144:147], v[28:31]
    ds_read2_b32 v[64:65], v7 offset0:32 offset1:33
    v_mfma_f32_16x16x32_bf16 v[32:35], v[112:115], v[148:151], v[32:35]
    ds_read2_b32 v[66:67], v7 offset0:34 offset1:35
    v_mfma_f32_16x16x32_bf16 v[36:39], v[112:115], v[152:155], v[36:39]
    ds_read_b128 v[96:99], v10 offset:10752
    v_mfma_f32_16x16x32_bf16 v[40:43], v[112:115], v[156:159], v[40:43]
    ds_read2_b32 v[68:69], v6 offset0:160 offset1:161
    v_mfma_f32_16x16x32_bf16 v[24:27], v[116:119], v[136:139], v[24:27]
    ds_read2_b32 v[70:71], v6 offset0:162 offset1:163
    v_mfma_f32_16x16x32_bf16 v[28:31], v[116:119], v[140:143], v[28:31]
    ds_read_b128 v[100:103], v10 offset:12800
    v_mfma_f32_16x16x32_bf16 v[32:35], v[116:119], v[144:147], v[32:35]
    ds_read2_b32 v[72:73], v6 offset0:32 offset1:33
    v_mfma_f32_16x16x32_bf16 v[36:39], v[116:119], v[148:151], v[36:39]
    ds_read2_b32 v[74:75], v6 offset0:34 offset1:35
    v_mfma_f32_16x16x32_bf16 v[40:43], v[116:119], v[152:155], v[40:43]
    ds_read_b128 v[164:167], v10 offset:14848
    v_mfma_f32_16x16x32_bf16 v[28:31], v[120:123], v[136:139], v[28:31]
    v_mfma_f32_16x16x32_bf16 v[32:35], v[120:123], v[140:143], v[32:35]
    v_mfma_f32_16x16x32_bf16 v[36:39], v[120:123], v[144:147], v[36:39]
    v_mfma_f32_16x16x32_bf16 v[40:43], v[120:123], v[148:151], v[40:43]
    v_mfma_f32_16x16x32_bf16 v[32:35], v[124:127], v[136:139], v[32:35]
    v_mfma_f32_16x16x32_bf16 v[36:39], v[124:127], v[140:143], v[36:39]
    v_mfma_f32_16x16x32_bf16 v[40:43], v[124:127], v[144:147], v[40:43]
    v_mfma_f32_16x16x32_bf16 v[36:39], v[128:131], v[136:139], v[36:39]
    v_mfma_f32_16x16x32_bf16 v[40:43], v[128:131], v[140:143], v[40:43]
    v_mfma_f32_16x16x32_bf16 v[40:43], v[132:135], v[136:139], v[40:43]
    s_waitcnt lgkmcnt(0)
    v_mfma_f32_16x16x32_bf16 v[40:43], v[44:47], v[164:167], v[40:43]
    v_mfma_f32_16x16x32_bf16 v[12:15], v[44:47], v[76:79], v[12:15]
    v_xor_b32 v11, 32, v11
    v_mfma_f32_16x16x32_bf16 v[16:19], v[44:47], v[80:83], v[16:19]
    ds_read2_b32 v[104:105], v9 offset0:176 offset1:177
    v_mfma_f32_16x16x32_bf16 v[20:23], v[44:47], v[84:87], v[20:23]
    ds_read2_b32 v[106:107], v9 offset0:178 offset1:179
    v_mfma_f32_16x16x32_bf16 v[24:27], v[44:47], v[88:91], v[24:27]
    ds_read_b128 v[136:139], v11 offset:512
    v_mfma_f32_16x16x32_bf16 v[28:31], v[44:47], v[92:95], v[28:31]
    ds_read2_b32 v[108:109], v9 offset0:48 offset1:49
    v_mfma_f32_16x16x32_bf16 v[32:35], v[44:47], v[96:99], v[32:35]
    ds_read2_b32 v[110:111], v9 offset0:50 offset1:51
    v_mfma_f32_16x16x32_bf16 v[36:39], v[44:47], v[100:103], v[36:39]
    ds_read_b128 v[140:143], v11 offset:2560
    v_mfma_f32_16x16x32_bf16 v[16:19], v[48:51], v[76:79], v[16:19]
    ds_read2_b32 v[112:113], v8 offset0:176 offset1:177
    v_mfma_f32_16x16x32_bf16 v[20:23], v[48:51], v[80:83], v[20:23]
    ds_read2_b32 v[114:115], v8 offset0:178 offset1:179
    v_mfma_f32_16x16x32_bf16 v[24:27], v[48:51], v[84:87], v[24:27]
    ds_read_b128 v[144:147], v11 offset:4608
    v_mfma_f32_16x16x32_bf16 v[28:31], v[48:51], v[88:91], v[28:31]
    ds_read2_b32 v[116:117], v8 offset0:48 offset1:49
    v_mfma_f32_16x16x32_bf16 v[32:35], v[48:51], v[92:95], v[32:35]
    ds_read2_b32 v[118:119], v8 offset0:50 offset1:51
    v_mfma_f32_16x16x32_bf16 v[36:39], v[48:51], v[96:99], v[36:39]
    ds_read_b128 v[148:151], v11 offset:6656
    v_mfma_f32_16x16x32_bf16 v[40:43], v[48:51], v[100:103], v[40:43]
    ds_read2_b32 v[120:121], v7 offset0:176 offset1:177
    v_mfma_f32_16x16x32_bf16 v[20:23], v[52:55], v[76:79], v[20:23]
    ds_read2_b32 v[122:123], v7 offset0:178 offset1:179
    v_mfma_f32_16x16x32_bf16 v[24:27], v[52:55], v[80:83], v[24:27]
    ds_read_b128 v[152:155], v11 offset:8704
    v_mfma_f32_16x16x32_bf16 v[28:31], v[52:55], v[84:87], v[28:31]
    ds_read2_b32 v[124:125], v7 offset0:48 offset1:49
    v_mfma_f32_16x16x32_bf16 v[32:35], v[52:55], v[88:91], v[32:35]
    ds_read2_b32 v[126:127], v7 offset0:50 offset1:51
    v_mfma_f32_16x16x32_bf16 v[36:39], v[52:55], v[92:95], v[36:39]
    ds_read_b128 v[156:159], v11 offset:10752
    v_mfma_f32_16x16x32_bf16 v[40:43], v[52:55], v[96:99], v[40:43]
    ds_read2_b32 v[128:129], v6 offset0:176 offset1:177
    v_mfma_f32_16x16x32_bf16 v[24:27], v[56:59], v[76:79], v[24:27]
    ds_read2_b32 v[130:131], v6 offset0:178 offset1:179
    v_mfma_f32_16x16x32_bf16 v[28:31], v[56:59], v[80:83], v[28:31]
    ds_read_b128 v[160:163], v11 offset:12800
    v_mfma_f32_16x16x32_bf16 v[32:35], v[56:59], v[84:87], v[32:35]
    ds_read2_b32 v[132:133], v6 offset0:48 offset1:49
    v_mfma_f32_16x16x32_bf16 v[36:39], v[56:59], v[88:91], v[36:39]
    ds_read2_b32 v[134:135], v6 offset0:50 offset1:51
    v_mfma_f32_16x16x32_bf16 v[40:43], v[56:59], v[92:95], v[40:43]
    ds_read_b128 v[164:167], v11 offset:14848
    v_mfma_f32_16x16x32_bf16 v[28:31], v[60:63], v[76:79], v[28:31]
    v_mfma_f32_16x16x32_bf16 v[32:35], v[60:63], v[80:83], v[32:35]
    v_mfma_f32_16x16x32_bf16 v[36:39], v[60:63], v[84:87], v[36:39]
    v_mfma_f32_16x16x32_bf16 v[40:43], v[60:63], v[88:91], v[40:43]
    v_mfma_f32_16x16x32_bf16 v[32:35], v[64:67], v[76:79], v[32:35]
    v_mfma_f32_16x16x32_bf16 v[36:39], v[64:67], v[80:83], v[36:39]
    v_mfma_f32_16x16x32_bf16 v[40:43], v[64:67], v[84:87], v[40:43]
    v_mfma_f32_16x16x32_bf16 v[36:39], v[68:71], v[76:79], v[36:39]
    v_mfma_f32_16x16x32_bf16 v[40:43], v[68:71], v[80:83], v[40:43]
    v_mfma_f32_16x16x32_bf16 v[40:43], v[72:75], v[76:79], v[40:43]
    s_waitcnt lgkmcnt(0)
    v_mfma_f32_16x16x32_bf16 v[40:43], v[104:107], v[164:167], v[40:43]
    v_mfma_f32_16x16x32_bf16 v[12:15], v[104:107], v[136:139], v[12:15]
    v_bfe_u32 v6, v0, 1, 4
    v_mfma_f32_16x16x32_bf16 v[16:19], v[104:107], v[140:143], v[16:19]
    v_and_b32 v7, 1, v0
    v_mfma_f32_16x16x32_bf16 v[20:23], v[104:107], v[144:147], v[20:23]
    v_mul_u32_u24 v7, 40, v7
    v_mfma_f32_16x16x32_bf16 v[24:27], v[104:107], v[148:151], v[24:27]
    v_xor_b32 v6, v6, v7
    v_mfma_f32_16x16x32_bf16 v[28:31], v[104:107], v[152:155], v[28:31]
    v_and_b32 v7, 32, v0
    v_mfma_f32_16x16x32_bf16 v[32:35], v[104:107], v[156:159], v[32:35]
    v_lshl_add_u32 v6, v7, 1, v6
    v_mfma_f32_16x16x32_bf16 v[36:39], v[104:107], v[160:163], v[36:39]
    s_lshl_b32 s5, s9, 12
    v_mfma_f32_16x16x32_bf16 v[16:19], v[108:111], v[136:139], v[16:19]
    s_add_u32 s5, s5, s15
    v_mfma_f32_16x16x32_bf16 v[20:23], v[108:111], v[140:143], v[20:23]
    v_lshl_add_u32 v6, v6, 4, s5
    v_mfma_f32_16x16x32_bf16 v[24:27], v[108:111], v[144:147], v[24:27]
    v_bfe_u32 v7, v0, 2, 2
    v_mfma_f32_16x16x32_bf16 v[28:31], v[108:111], v[148:151], v[28:31]
    v_xor_b32 v7, s8, v7
    v_mfma_f32_16x16x32_bf16 v[32:35], v[108:111], v[152:155], v[32:35]
    v_lshlrev_b32 v7, 4, v7
    v_mfma_f32_16x16x32_bf16 v[36:39], v[108:111], v[156:159], v[36:39]
    v_lshl_add_u32 v7, v0, 6, v7
    v_mfma_f32_16x16x32_bf16 v[40:43], v[108:111], v[160:163], v[40:43]
    s_lshl_b32 s5, s9, 13
    v_mfma_f32_16x16x32_bf16 v[20:23], v[112:115], v[136:139], v[20:23]
    s_add_u32 s5, s5, 34816
    v_mfma_f32_16x16x32_bf16 v[24:27], v[112:115], v[140:143], v[24:27]
    v_add_u32 v7, s5, v7
    v_mfma_f32_16x16x32_bf16 v[28:31], v[112:115], v[144:147], v[28:31]
    ds_read_b128 v[44:47], v7
    v_mfma_f32_16x16x32_bf16 v[32:35], v[112:115], v[148:151], v[32:35]
    ds_read_b128 v[48:51], v7 offset:4096
    v_mfma_f32_16x16x32_bf16 v[36:39], v[112:115], v[152:155], v[36:39]
    v_lshrrev_b32 v8, 2, v0
    v_mfma_f32_16x16x32_bf16 v[40:43], v[112:115], v[156:159], v[40:43]
    v_mul_u32_u24 v8, 36864, v8
    v_mfma_f32_16x16x32_bf16 v[24:27], v[116:119], v[136:139], v[24:27]
    v_and_b32 v9, 3, v0
    v_mfma_f32_16x16x32_bf16 v[28:31], v[116:119], v[140:143], v[28:31]
    v_lshl_add_u32 v8, v9, 4, v8
    v_mfma_f32_16x16x32_bf16 v[32:35], v[116:119], v[144:147], v[32:35]
    s_add_u32 s26, s24, 589824
    v_mfma_f32_16x16x32_bf16 v[36:39], v[116:119], v[148:151], v[36:39]
    v_mfma_f32_16x16x32_bf16 v[40:43], v[116:119], v[152:155], v[40:43]
    v_mfma_f32_16x16x32_bf16 v[28:31], v[120:123], v[136:139], v[28:31]
    v_mfma_f32_16x16x32_bf16 v[32:35], v[120:123], v[140:143], v[32:35]
    v_mfma_f32_16x16x32_bf16 v[36:39], v[120:123], v[144:147], v[36:39]
    v_mfma_f32_16x16x32_bf16 v[40:43], v[120:123], v[148:151], v[40:43]
    v_mfma_f32_16x16x32_bf16 v[32:35], v[124:127], v[136:139], v[32:35]
    v_mfma_f32_16x16x32_bf16 v[36:39], v[124:127], v[140:143], v[36:39]
    v_mfma_f32_16x16x32_bf16 v[40:43], v[124:127], v[144:147], v[40:43]
    v_mfma_f32_16x16x32_bf16 v[36:39], v[128:131], v[136:139], v[36:39]
    v_mfma_f32_16x16x32_bf16 v[40:43], v[128:131], v[140:143], v[40:43]
    v_mfma_f32_16x16x32_bf16 v[40:43], v[132:135], v[136:139], v[40:43]
    s_waitcnt lgkmcnt(0)
    v_lshlrev_b32 v52, 16, v44
    v_and_b32 v53, s73, v44
    v_lshlrev_b32 v54, 16, v45
    v_and_b32 v55, s73, v45
    v_lshlrev_b32 v56, 16, v46
    v_and_b32 v57, s73, v46
    v_lshlrev_b32 v58, 16, v47
    v_and_b32 v59, s73, v47
    ds_write_b128 v5, v[12:15] offset:0
    ds_write_b128 v5, v[16:19] offset:1024
    ds_write_b128 v5, v[20:23] offset:2048
    ds_write_b128 v5, v[24:27] offset:3072
    ds_write_b128 v5, v[28:31] offset:4096
    ds_write_b128 v5, v[32:35] offset:5120
    ds_write_b128 v5, v[36:39] offset:6144
    ds_write_b128 v5, v[40:43] offset:7168
    v_lshlrev_b32 v60, 16, v48
    v_and_b32 v61, s73, v48
    v_lshlrev_b32 v62, 16, v49
    v_and_b32 v63, s73, v49
    v_lshlrev_b32 v64, 16, v50
    v_and_b32 v65, s73, v50
    v_lshlrev_b32 v66, 16, v51
    v_and_b32 v67, s73, v51
    v_mul_f32 v52, s20, v52
    v_mul_f32 v53, s20, v53
    v_mul_f32 v54, s20, v54
    v_mul_f32 v55, s20, v55
    v_mul_f32 v56, s20, v56
    v_mul_f32 v57, s20, v57
    v_mul_f32 v58, s20, v58
    v_mul_f32 v59, s20, v59
    v_mul_f32 v60, s20, v60
    v_mul_f32 v61, s20, v61
    v_mul_f32 v62, s20, v62
    v_mul_f32 v63, s20, v63
    v_mul_f32 v64, s20, v64
    v_mul_f32 v65, s20, v65
    v_mul_f32 v66, s20, v66
    v_mul_f32 v67, s20, v67
    s_waitcnt lgkmcnt(0)
    s_mov_b64 exec, 1
    ds_add_u32 v4, v1 offset:80
    s_mov_b64 exec, -1
    v_cvt_pk_bf16_f32 v44, v52, v53
    v_cvt_pk_bf16_f32 v45, v54, v55
    v_cvt_pk_bf16_f32 v46, v56, v57
    v_cvt_pk_bf16_f32 v47, v58, v59
    v_cvt_pk_bf16_f32 v48, v60, v61
    v_cvt_pk_bf16_f32 v49, v62, v63
    v_cvt_pk_bf16_f32 v50, v64, v65
    v_cvt_pk_bf16_f32 v51, v66, v67
    v_lshlrev_b32 v52, 16, v44
    v_and_b32 v53, s73, v44
    v_lshlrev_b32 v54, 16, v45
    v_and_b32 v55, s73, v45
    v_lshlrev_b32 v56, 16, v46
    v_and_b32 v57, s73, v46
    v_lshlrev_b32 v58, 16, v47
    v_and_b32 v59, s73, v47
    v_lshlrev_b32 v60, 16, v48
    v_and_b32 v61, s73, v48
    v_lshlrev_b32 v62, 16, v49
    v_and_b32 v63, s73, v49
    v_lshlrev_b32 v64, 16, v50
    v_and_b32 v65, s73, v50
    v_lshlrev_b32 v66, 16, v51
    v_and_b32 v67, s73, v51
    s_mov_b32 s97, 4194304
C_PW:
    ds_read_b32 v2, v4 offset:80
    ds_read_b128 v[68:71], v6 offset:0
    ds_read_b128 v[72:75], v6 offset:256
    ds_read_b128 v[76:79], v6 offset:8192
    ds_read_b128 v[80:83], v6 offset:8448
    ds_read_b128 v[84:87], v6 offset:2048
    ds_read_b128 v[88:91], v6 offset:2304
    ds_read_b128 v[92:95], v6 offset:10240
    ds_read_b128 v[96:99], v6 offset:10496
    s_waitcnt lgkmcnt(0)
    v_readfirstlane_b32 s96, v2
    s_cmp_ge_u32 s96, 2
    s_cbranch_scc1 C_PWOK
    s_sub_u32 s97, s97, 1
    s_cbranch_scc0 C_PW
C_PWOK:
    v_add_f32 v68, v68, v76
    v_add_f32 v69, v69, v77
    v_add_f32 v70, v70, v78
    v_add_f32 v71, v71, v79
    v_add_f32 v72, v72, v80
    v_add_f32 v73, v73, v81
    v_add_f32 v74, v74, v82
    v_add_f32 v75, v75, v83
    v_cvt_pk_bf16_f32 v76, v68, v69
    v_cvt_pk_bf16_f32 v77, v70, v71
    v_cvt_pk_bf16_f32 v78, v72, v73
    v_cvt_pk_bf16_f32 v79, v74, v75
    v_lshlrev_b32 v68, 16, v76
    v_and_b32 v69, s73, v76
    v_lshlrev_b32 v70, 16, v77
    v_and_b32 v71, s73, v77
    v_lshlrev_b32 v72, 16, v78
    v_and_b32 v73, s73, v78
    v_lshlrev_b32 v74, 16, v79
    v_and_b32 v75, s73, v79
    v_add_f32 v68, v68, v52
    v_add_f32 v69, v69, v53
    v_add_f32 v70, v70, v54
    v_add_f32 v71, v71, v55
    v_add_f32 v72, v72, v56
    v_add_f32 v73, v73, v57
    v_add_f32 v74, v74, v58
    v_add_f32 v75, v75, v59
    v_cvt_pk_bf16_f32 v44, v68, v69
    v_cvt_pk_bf16_f32 v45, v70, v71
    v_cvt_pk_bf16_f32 v46, v72, v73
    v_cvt_pk_bf16_f32 v47, v74, v75
    buffer_store_dwordx4 v[44:47], v8, s[16:19], s24 offen sc1
    v_add_f32 v84, v84, v92
    v_add_f32 v85, v85, v93
    v_add_f32 v86, v86, v94
    v_add_f32 v87, v87, v95
    v_add_f32 v88, v88, v96
    v_add_f32 v89, v89, v97
    v_add_f32 v90, v90, v98
    v_add_f32 v91, v91, v99
    v_cvt_pk_bf16_f32 v92, v84, v85
    v_cvt_pk_bf16_f32 v93, v86, v87
    v_cvt_pk_bf16_f32 v94, v88, v89
    v_cvt_pk_bf16_f32 v95, v90, v91
    v_lshlrev_b32 v84, 16, v92
    v_and_b32 v85, s73, v92
    v_lshlrev_b32 v86, 16, v93
    v_and_b32 v87, s73, v93
    v_lshlrev_b32 v88, 16, v94
    v_and_b32 v89, s73, v94
    v_lshlrev_b32 v90, 16, v95
    v_and_b32 v91, s73, v95
    v_add_f32 v84, v84, v60
    v_add_f32 v85, v85, v61
    v_add_f32 v86, v86, v62
    v_add_f32 v87, v87, v63
    v_add_f32 v88, v88, v64
    v_add_f32 v89, v89, v65
    v_add_f32 v90, v90, v66
    v_add_f32 v91, v91, v67
    v_cvt_pk_bf16_f32 v48, v84, v85
    v_cvt_pk_bf16_f32 v49, v86, v87
    v_cvt_pk_bf16_f32 v50, v88, v89
    v_cvt_pk_bf16_f32 v51, v90, v91
    buffer_store_dwordx4 v[48:51], v8, s[16:19], s26 offen sc1
    s_mov_b32 s97, 4194304
LW_36:
    ds_read_b32 v2, v3 offset:96
    s_waitcnt lgkmcnt(0)
    v_readfirstlane_b32 s96, v2
    s_cmp_ge_u32 s96, 1
    s_cbranch_scc1 LWOK_37
    s_sub_u32 s97, s97, 1
    s_cbranch_scc0 LW_36
LWOK_37:
    s_mov_b32 s74, s96
    s_lshl_b32 s13, s30, 2
    s_sub_u32 s13, s13, 1
    s_lshr_b32 s14, s13, 1
    s_waitcnt vmcnt(0)
    s_mov_b64 exec, 1
    ds_add_rtn_u32 v2, v3, v1 offset:120
    s_mov_b64 exec, -1
    s_waitcnt lgkmcnt(0)
    v_readfirstlane_b32 s96, v2
    s_cmp_lg_u32 s96, s13
    s_cbranch_scc1 C_END
    v_lshlrev_b32 v100, 7, v0
    v_mov_b32 v101, s74
    s_mov_b32 exec_lo, s14
    s_mov_b32 exec_hi, 0
    buffer_store_dword v101, v100, s[16:19], s25 offen sc1
    s_mov_b64 exec, 1
    ds_add_u32 v3, v1 offset:36
    s_mov_b64 exec, -1
C_END:
    v_and_b32 v4, 31, v0
    v_lshrrev_b32 v5, 5, v0
    s_cmp_lt_u32 s3, 8
    s_cbranch_scc1 F_ATTN
    s_cmp_lg_u32 s3, 11
    s_cbranch_scc1 F_FIN
    s_setprio 3
    s_cmp_lt_u32 s2, 192
    s_cbranch_scc1 M_GATE
    s_endpgm
K_U5:
    s_waitcnt lgkmcnt(0)
    s_cmp_lg_u32 s74, 0
    s_cbranch_scc1 K_NOK
    s_sleep 8
    s_load_dword s74, s[56:57], 64
    s_waitcnt lgkmcnt(0)
    s_cmp_lg_u32 s74, 0
    s_cbranch_scc1 K_NOK
    s_sleep 8
    s_load_dword s74, s[56:57], 128
    s_waitcnt lgkmcnt(0)
    s_cmp_lg_u32 s74, 0
    s_cbranch_scc1 K_NOK
    s_sleep 8
    s_load_dword s74, s[56:57], 192
    s_waitcnt lgkmcnt(0)
    s_cmp_lg_u32 s74, 0
    s_cbranch_scc1 K_NOK
    s_sleep 8
    s_mov_b32 s97, 262144
    v_mov_b32 v158, 0
K_NL:
    global_load_dword v159, v158, s[56:57] sc1
    s_waitcnt vmcnt(0)
    v_readfirstlane_b32 s74, v159
    s_cmp_lg_u32 s74, 0
    s_cbranch_scc1 K_NOK
    s_sub_u32 s97, s97, 1
    s_cbranch_scc0 K_NL
    s_mov_b32 s74, 1
K_NOK:
    v_mov_b32 v159, s74
    s_waitcnt vmcnt(0)
    v_mov_b32 v158, 0
    v_mov_b32 v159, s74
    s_mov_b64 exec, 1
    buffer_store_dword v159, v158, s[16:19], s65 offen sc1
    s_mov_b64 exec, -1
    s_branch K_UB5
F_GATE:
    s_and_b32 s4, s2, 3
    s_lshl_b32 s4, s4, 6
    s_lshr_b32 s5, s2, 2
    s_add_u32 s4, s4, s5
    s_mul_i32 s5, s4, 9216
    v_and_b32 v8, 7, v0
    v_lshlrev_b32 v8, 4, v8
    v_lshrrev_b32 v11, 3, v0
    v_mul_u32_u24 v10, 1152, v11
    v_add3_u32 v10, v10, v8, s5
    global_load_dwordx4 v[72:75], v10, s[32:33] offset:0
    global_load_dwordx4 v[76:79], v10, s[32:33] offset:128
    global_load_dwordx4 v[80:83], v10, s[32:33] offset:256
    global_load_dwordx4 v[84:87], v10, s[32:33] offset:384
    global_load_dwordx4 v[88:91], v10, s[32:33] offset:512
    global_load_dwordx4 v[92:95], v10, s[32:33] offset:640
    global_load_dwordx4 v[96:99], v10, s[32:33] offset:768
    global_load_dwordx4 v[100:103], v10, s[32:33] offset:896
    global_load_dwordx4 v[104:107], v10, s[32:33] offset:1024
    global_load_dwordx4 v[108:111], v8, s[52:53] offset:0
    global_load_dwordx4 v[112:115], v8, s[52:53] offset:128
    global_load_dwordx4 v[116:119], v8, s[52:53] offset:256
    global_load_dwordx4 v[120:123], v8, s[52:53] offset:384
    global_load_dwordx4 v[124:127], v8, s[52:53] offset:512
    global_load_dwordx4 v[128:131], v8, s[52:53] offset:640
    global_load_dwordx4 v[132:135], v8, s[52:53] offset:768
    global_load_dwordx4 v[136:139], v8, s[52:53] offset:896
    global_load_dwordx4 v[140:143], v8, s[52:53] offset:1024
    s_cmp_ge_u32 s2, 224
    s_cbranch_scc1 T_NB
    s_waitcnt vmcnt(18)
    s_barrier
T_NB:
    s_mov_b32 s97, 4194304
LW_38:
    ds_read_b32 v2, v3 offset:96
    s_waitcnt lgkmcnt(0)
    v_readfirstlane_b32 s96, v2
    s_cmp_ge_u32 s96, 1
    s_cbranch_scc1 LWOK_39
    s_sub_u32 s97, s97, 1
    s_cbranch_scc0 LW_38
LWOK_39:
    s_mov_b32 s74, s96
    s_waitcnt vmcnt(0)
    s_mov_b32 s73, 0xffff0000
    v_mov_b32 v16, 0
    v_mov_b32 v17, 0
    v_mov_b32 v18, 0
    v_mov_b32 v19, 0
    v_mov_b32 v20, 0
    v_mov_b32 v21, 0
    v_mov_b32 v22, 0
    v_mov_b32 v23, 0
    s_waitcnt lgkmcnt(0)
    v_lshlrev_b32 v32, 16, v72
    v_and_b32 v33, s73, v72
    v_lshlrev_b32 v40, 16, v108
    v_and_b32 v41, s73, v108
    v_lshlrev_b32 v34, 16, v73
    v_and_b32 v35, s73, v73
    v_lshlrev_b32 v42, 16, v109
    v_and_b32 v43, s73, v109
    v_lshlrev_b32 v36, 16, v74
    v_and_b32 v37, s73, v74
    v_lshlrev_b32 v44, 16, v110
    v_and_b32 v45, s73, v110
    v_lshlrev_b32 v38, 16, v75
    v_and_b32 v39, s73, v75
    v_lshlrev_b32 v46, 16, v111
    v_and_b32 v47, s73, v111
    v_pk_mul_f32 v[32:33], v[32:33], v[40:41]
    v_pk_mul_f32 v[34:35], v[34:35], v[42:43]
    v_pk_mul_f32 v[36:37], v[36:37], v[44:45]
    v_pk_mul_f32 v[38:39], v[38:39], v[46:47]
    v_cvt_pk_bf16_f32 v40, v32, v33
    v_cvt_pk_bf16_f32 v41, v34, v35
    v_cvt_pk_bf16_f32 v42, v36, v37
    v_cvt_pk_bf16_f32 v43, v38, v39
    v_lshlrev_b32 v32, 16, v40
    v_and_b32 v33, s73, v40
    v_lshlrev_b32 v34, 16, v41
    v_and_b32 v35, s73, v41
    v_lshlrev_b32 v36, 16, v42
    v_and_b32 v37, s73, v42
    v_lshlrev_b32 v38, 16, v43
    v_and_b32 v39, s73, v43
    v_pk_add_f32 v[16:17], v[16:17], v[32:33]
    v_pk_add_f32 v[18:19], v[18:19], v[34:35]
    v_pk_add_f32 v[20:21], v[20:21], v[36:37]
    v_pk_add_f32 v[22:23], v[22:23], v[38:39]
    v_lshlrev_b32 v32, 16, v76
    v_and_b32 v33, s73, v76
    v_lshlrev_b32 v40, 16, v112
    v_and_b32 v41, s73, v112
    v_lshlrev_b32 v34, 16, v77
    v_and_b32 v35, s73, v77
    v_lshlrev_b32 v42, 16, v113
    v_and_b32 v43, s73, v113
    v_lshlrev_b32 v36, 16, v78
    v_and_b32 v37, s73, v78
    v_lshlrev_b32 v44, 16, v114
    v_and_b32 v45, s73, v114
    v_lshlrev_b32 v38, 16, v79
    v_and_b32 v39, s73, v79
    v_lshlrev_b32 v46, 16, v115
    v_and_b32 v47, s73, v115
    v_pk_mul_f32 v[32:33], v[32:33], v[40:41]
    v_pk_mul_f32 v[34:35], v[34:35], v[42:43]
    v_pk_mul_f32 v[36:37], v[36:37], v[44:45]
    v_pk_mul_f32 v[38:39], v[38:39], v[46:47]
    v_cvt_pk_bf16_f32 v40, v32, v33
    v_cvt_pk_bf16_f32 v41, v34, v35
    v_cvt_pk_bf16_f32 v42, v36, v37
    v_cvt_pk_bf16_f32 v43, v38, v39
    v_lshlrev_b32 v32, 16, v40
    v_and_b32 v33, s73, v40
    v_lshlrev_b32 v34, 16, v41
    v_and_b32 v35, s73, v41
    v_lshlrev_b32 v36, 16, v42
    v_and_b32 v37, s73, v42
    v_lshlrev_b32 v38, 16, v43
    v_and_b32 v39, s73, v43
    v_pk_add_f32 v[16:17], v[16:17], v[32:33]
    v_pk_add_f32 v[18:19], v[18:19], v[34:35]
    v_pk_add_f32 v[20:21], v[20:21], v[36:37]
    v_pk_add_f32 v[22:23], v[22:23], v[38:39]
    v_lshlrev_b32 v32, 16, v80
    v_and_b32 v33, s73, v80
    v_lshlrev_b32 v40, 16, v116
    v_and_b32 v41, s73, v116
    v_lshlrev_b32 v34, 16, v81
    v_and_b32 v35, s73, v81
    v_lshlrev_b32 v42, 16, v117
    v_and_b32 v43, s73, v117
    v_lshlrev_b32 v36, 16, v82
    v_and_b32 v37, s73, v82
    v_lshlrev_b32 v44, 16, v118
    v_and_b32 v45, s73, v118
    v_lshlrev_b32 v38, 16, v83
    v_and_b32 v39, s73, v83
    v_lshlrev_b32 v46, 16, v119
    v_and_b32 v47, s73, v119
    v_pk_mul_f32 v[32:33], v[32:33], v[40:41]
    v_pk_mul_f32 v[34:35], v[34:35], v[42:43]
    v_pk_mul_f32 v[36:37], v[36:37], v[44:45]
    v_pk_mul_f32 v[38:39], v[38:39], v[46:47]
    v_cvt_pk_bf16_f32 v40, v32, v33
    v_cvt_pk_bf16_f32 v41, v34, v35
    v_cvt_pk_bf16_f32 v42, v36, v37
    v_cvt_pk_bf16_f32 v43, v38, v39
    v_lshlrev_b32 v32, 16, v40
    v_and_b32 v33, s73, v40
    v_lshlrev_b32 v34, 16, v41
    v_and_b32 v35, s73, v41
    v_lshlrev_b32 v36, 16, v42
    v_and_b32 v37, s73, v42
    v_lshlrev_b32 v38, 16, v43
    v_and_b32 v39, s73, v43
    v_pk_add_f32 v[16:17], v[16:17], v[32:33]
    v_pk_add_f32 v[18:19], v[18:19], v[34:35]
    v_pk_add_f32 v[20:21], v[20:21], v[36:37]
    v_pk_add_f32 v[22:23], v[22:23], v[38:39]
    v_lshlrev_b32 v32, 16, v84
    v_and_b32 v33, s73, v84
    v_lshlrev_b32 v40, 16, v120
    v_and_b32 v41, s73, v120
    v_lshlrev_b32 v34, 16, v85
    v_and_b32 v35, s73, v85
    v_lshlrev_b32 v42, 16, v121
    v_and_b32 v43, s73, v121
    v_lshlrev_b32 v36, 16, v86
    v_and_b32 v37, s73, v86
    v_lshlrev_b32 v44, 16, v122
    v_and_b32 v45, s73, v122
    v_lshlrev_b32 v38, 16, v87
    v_and_b32 v39, s73, v87
    v_lshlrev_b32 v46, 16, v123
    v_and_b32 v47, s73, v123
    v_pk_mul_f32 v[32:33], v[32:33], v[40:41]
    v_pk_mul_f32 v[34:35], v[34:35], v[42:43]
    v_pk_mul_f32 v[36:37], v[36:37], v[44:45]
    v_pk_mul_f32 v[38:39], v[38:39], v[46:47]
    v_cvt_pk_bf16_f32 v40, v32, v33
    v_cvt_pk_bf16_f32 v41, v34, v35
    v_cvt_pk_bf16_f32 v42, v36, v37
    v_cvt_pk_bf16_f32 v43, v38, v39
    v_lshlrev_b32 v32, 16, v40
    v_and_b32 v33, s73, v40
    v_lshlrev_b32 v34, 16, v41
    v_and_b32 v35, s73, v41
    v_lshlrev_b32 v36, 16, v42
    v_and_b32 v37, s73, v42
    v_lshlrev_b32 v38, 16, v43
    v_and_b32 v39, s73, v43
    v_pk_add_f32 v[16:17], v[16:17], v[32:33]
    v_pk_add_f32 v[18:19], v[18:19], v[34:35]
    v_pk_add_f32 v[20:21], v[20:21], v[36:37]
    v_pk_add_f32 v[22:23], v[22:23], v[38:39]
    v_lshlrev_b32 v32, 16, v88
    v_and_b32 v33, s73, v88
    v_lshlrev_b32 v40, 16, v124
    v_and_b32 v41, s73, v124
    v_lshlrev_b32 v34, 16, v89
    v_and_b32 v35, s73, v89
    v_lshlrev_b32 v42, 16, v125
    v_and_b32 v43, s73, v125
    v_lshlrev_b32 v36, 16, v90
    v_and_b32 v37, s73, v90
    v_lshlrev_b32 v44, 16, v126
    v_and_b32 v45, s73, v126
    v_lshlrev_b32 v38, 16, v91
    v_and_b32 v39, s73, v91
    v_lshlrev_b32 v46, 16, v127
    v_and_b32 v47, s73, v127
    v_pk_mul_f32 v[32:33], v[32:33], v[40:41]
    v_pk_mul_f32 v[34:35], v[34:35], v[42:43]
    v_pk_mul_f32 v[36:37], v[36:37], v[44:45]
    v_pk_mul_f32 v[38:39], v[38:39], v[46:47]
    v_cvt_pk_bf16_f32 v40, v32, v33
    v_cvt_pk_bf16_f32 v41, v34, v35
    v_cvt_pk_bf16_f32 v42, v36, v37
    v_cvt_pk_bf16_f32 v43, v38, v39
    v_lshlrev_b32 v32, 16, v40
    v_and_b32 v33, s73, v40
    v_lshlrev_b32 v34, 16, v41
    v_and_b32 v35, s73, v41
    v_lshlrev_b32 v36, 16, v42
    v_and_b32 v37, s73, v42
    v_lshlrev_b32 v38, 16, v43
    v_and_b32 v39, s73, v43
    v_pk_add_f32 v[16:17], v[16:17], v[32:33]
    v_pk_add_f32 v[18:19], v[18:19], v[34:35]
    v_pk_add_f32 v[20:21], v[20:21], v[36:37]
    v_pk_add_f32 v[22:23], v[22:23], v[38:39]
    v_lshlrev_b32 v32, 16, v92
    v_and_b32 v33, s73, v92
    v_lshlrev_b32 v40, 16, v128
    v_and_b32 v41, s73, v128
    v_lshlrev_b32 v34, 16, v93
    v_and_b32 v35, s73, v93
    v_lshlrev_b32 v42, 16, v129
    v_and_b32 v43, s73, v129
    v_lshlrev_b32 v36, 16, v94
    v_and_b32 v37, s73, v94
    v_lshlrev_b32 v44, 16, v130
    v_and_b32 v45, s73, v130
    v_lshlrev_b32 v38, 16, v95
    v_and_b32 v39, s73, v95
    v_lshlrev_b32 v46, 16, v131
    v_and_b32 v47, s73, v131
    v_pk_mul_f32 v[32:33], v[32:33], v[40:41]
    v_pk_mul_f32 v[34:35], v[34:35], v[42:43]
    v_pk_mul_f32 v[36:37], v[36:37], v[44:45]
    v_pk_mul_f32 v[38:39], v[38:39], v[46:47]
    v_cvt_pk_bf16_f32 v40, v32, v33
    v_cvt_pk_bf16_f32 v41, v34, v35
    v_cvt_pk_bf16_f32 v42, v36, v37
    v_cvt_pk_bf16_f32 v43, v38, v39
    v_lshlrev_b32 v32, 16, v40
    v_and_b32 v33, s73, v40
    v_lshlrev_b32 v34, 16, v41
    v_and_b32 v35, s73, v41
    v_lshlrev_b32 v36, 16, v42
    v_and_b32 v37, s73, v42
    v_lshlrev_b32 v38, 16, v43
    v_and_b32 v39, s73, v43
    v_pk_add_f32 v[16:17], v[16:17], v[32:33]
    v_pk_add_f32 v[18:19], v[18:19], v[34:35]
    v_pk_add_f32 v[20:21], v[20:21], v[36:37]
    v_pk_add_f32 v[22:23], v[22:23], v[38:39]
    v_lshlrev_b32 v32, 16, v96
    v_and_b32 v33, s73, v96
    v_lshlrev_b32 v40, 16, v132
    v_and_b32 v41, s73, v132
    v_lshlrev_b32 v34, 16, v97
    v_and_b32 v35, s73, v97
    v_lshlrev_b32 v42, 16, v133
    v_and_b32 v43, s73, v133
    v_lshlrev_b32 v36, 16, v98
    v_and_b32 v37, s73, v98
    v_lshlrev_b32 v44, 16, v134
    v_and_b32 v45, s73, v134
    v_lshlrev_b32 v38, 16, v99
    v_and_b32 v39, s73, v99
    v_lshlrev_b32 v46, 16, v135
    v_and_b32 v47, s73, v135
    v_pk_mul_f32 v[32:33], v[32:33], v[40:41]
    v_pk_mul_f32 v[34:35], v[34:35], v[42:43]
    v_pk_mul_f32 v[36:37], v[36:37], v[44:45]
    v_pk_mul_f32 v[38:39], v[38:39], v[46:47]
    v_cvt_pk_bf16_f32 v40, v32, v33
    v_cvt_pk_bf16_f32 v41, v34, v35
    v_cvt_pk_bf16_f32 v42, v36, v37
    v_cvt_pk_bf16_f32 v43, v38, v39
    v_lshlrev_b32 v32, 16, v40
    v_and_b32 v33, s73, v40
    v_lshlrev_b32 v34, 16, v41
    v_and_b32 v35, s73, v41
    v_lshlrev_b32 v36, 16, v42
    v_and_b32 v37, s73, v42
    v_lshlrev_b32 v38, 16, v43
    v_and_b32 v39, s73, v43
    v_pk_add_f32 v[16:17], v[16:17], v[32:33]
    v_pk_add_f32 v[18:19], v[18:19], v[34:35]
    v_pk_add_f32 v[20:21], v[20:21], v[36:37]
    v_pk_add_f32 v[22:23], v[22:23], v[38:39]
    v_lshlrev_b32 v32, 16, v100
    v_and_b32 v33, s73, v100
    v_lshlrev_b32 v40, 16, v136
    v_and_b32 v41, s73, v136
    v_lshlrev_b32 v34, 16, v101
    v_and_b32 v35, s73, v101
    v_lshlrev_b32 v42, 16, v137
    v_and_b32 v43, s73, v137
    v_lshlrev_b32 v36, 16, v102
    v_and_b32 v37, s73, v102
    v_lshlrev_b32 v44, 16, v138
    v_and_b32 v45, s73, v138
    v_lshlrev_b32 v38, 16, v103
    v_and_b32 v39, s73, v103
    v_lshlrev_b32 v46, 16, v139
    v_and_b32 v47, s73, v139
    v_pk_mul_f32 v[32:33], v[32:33], v[40:41]
    v_pk_mul_f32 v[34:35], v[34:35], v[42:43]
    v_pk_mul_f32 v[36:37], v[36:37], v[44:45]
    v_pk_mul_f32 v[38:39], v[38:39], v[46:47]
    v_cvt_pk_bf16_f32 v40, v32, v33
    v_cvt_pk_bf16_f32 v41, v34, v35
    v_cvt_pk_bf16_f32 v42, v36, v37
    v_cvt_pk_bf16_f32 v43, v38, v39
    v_lshlrev_b32 v32, 16, v40
    v_and_b32 v33, s73, v40
    v_lshlrev_b32 v34, 16, v41
    v_and_b32 v35, s73, v41
    v_lshlrev_b32 v36, 16, v42
    v_and_b32 v37, s73, v42
    v_lshlrev_b32 v38, 16, v43
    v_and_b32 v39, s73, v43
    v_pk_add_f32 v[16:17], v[16:17], v[32:33]
    v_pk_add_f32 v[18:19], v[18:19], v[34:35]
    v_pk_add_f32 v[20:21], v[20:21], v[36:37]
    v_pk_add_f32 v[22:23], v[22:23], v[38:39]
    v_lshlrev_b32 v32, 16, v104
    v_and_b32 v33, s73, v104
    v_lshlrev_b32 v40, 16, v140
    v_and_b32 v41, s73, v140
    v_lshlrev_b32 v34, 16, v105
    v_and_b32 v35, s73, v105
    v_lshlrev_b32 v42, 16, v141
    v_and_b32 v43, s73, v141
    v_lshlrev_b32 v36, 16, v106
    v_and_b32 v37, s73, v106
    v_lshlrev_b32 v44, 16, v142
    v_and_b32 v45, s73, v142
    v_lshlrev_b32 v38, 16, v107
    v_and_b32 v39, s73, v107
    v_lshlrev_b32 v46, 16, v143
    v_and_b32 v47, s73, v143
    v_pk_mul_f32 v[32:33], v[32:33], v[40:41]
    v_pk_mul_f32 v[34:35], v[34:35], v[42:43]
    v_pk_mul_f32 v[36:37], v[36:37], v[44:45]
    v_pk_mul_f32 v[38:39], v[38:39], v[46:47]
    v_cvt_pk_bf16_f32 v40, v32, v33
    v_cvt_pk_bf16_f32 v41, v34, v35
    v_cvt_pk_bf16_f32 v42, v36, v37
    v_cvt_pk_bf16_f32 v43, v38, v39
    v_lshlrev_b32 v32, 16, v40
    v_and_b32 v33, s73, v40
    v_lshlrev_b32 v34, 16, v41
    v_and_b32 v35, s73, v41
    v_lshlrev_b32 v36, 16, v42
    v_and_b32 v37, s73, v42
    v_lshlrev_b32 v38, 16, v43
    v_and_b32 v39, s73, v43
    v_pk_add_f32 v[16:17], v[16:17], v[32:33]
    v_pk_add_f32 v[18:19], v[18:19], v[34:35]
    v_pk_add_f32 v[20:21], v[20:21], v[36:37]
    v_pk_add_f32 v[22:23], v[22:23], v[38:39]
    v_pk_add_f32 v[16:17], v[16:17], v[18:19]
    v_pk_add_f32 v[20:21], v[20:21], v[22:23]
    v_pk_add_f32 v[16:17], v[16:17], v[20:21]
    v_add_f32 v24, v16, v17
    s_nop 1
    v_add_f32_dpp v24, v24, v24 quad_perm:[1,0,3,2] row_mask:0xf bank_mask:0xf
    s_nop 1
    v_add_f32_dpp v24, v24, v24 quad_perm:[2,3,0,1] row_mask:0xf bank_mask:0xf
    s_nop 1
    v_add_f32_dpp v24, v24, v24 row_half_mirror row_mask:0xf bank_mask:0xf
    v_cvt_pk_bf16_f32 v24, v24, v24
    v_and_b32 v24, s73, v24
    v_mul_f32 v24, 0xbfb8aa3b, v24
    v_exp_f32 v24, v24
    s_nop 0
    v_add_f32 v24, 1.0, v24
    v_rcp_f32 v24, v24
    s_nop 0
    v_cvt_pk_bf16_f32 v24, v24, v24
    v_and_b32 v24, s73, v24
    v_sub_f32 v25, 1.0, v24
    v_cvt_pk_bf16_f32 v25, v25, v25
    v_and_b32 v25, s73, v25
    v_lshlrev_b32 v11, 3, v11
    s_lshl_b32 s7, s4, 6
    s_add_u32 s7, s7, 14819328
    s_mov_b32 exec_lo, 0x01010101
    s_mov_b32 exec_hi, 0x01010101
    buffer_store_dwordx2 v[24:25], v11, s[16:19], s7 offen sc1
    s_mov_b64 exec, -1
    s_lshl_b32 s7, s4, 7
    s_add_u32 s7, s7, 14884864
    s_waitcnt vmcnt(0)
    v_mov_b32 v12, 0
    v_mov_b32 v13, s74
    s_mov_b64 exec, 1
    buffer_store_dword v13, v12, s[16:19], s7 offen sc1
    s_mov_b64 exec, -1
    s_branch F_ATTN
M_GATE:
    v_lshlrev_b32 v6, 4, v0
    v_add_u32 v7, 0, v0
    v_mul_u32_u24 v8, 171, v7
    v_lshrrev_b32 v8, 11, v8
    v_mul_u32_u24 v8, 960, v8
    v_add_u32 v20, v8, v6
    v_add_u32 v7, 64, v0
    v_mul_u32_u24 v8, 171, v7
    v_lshrrev_b32 v8, 11, v8
    v_mul_u32_u24 v8, 960, v8
    v_add_u32 v21, v8, v6
    v_add_u32 v7, 128, v0
    v_mul_u32_u24 v8, 171, v7
    v_lshrrev_b32 v8, 11, v8
    v_mul_u32_u24 v8, 960, v8
    v_add_u32 v22, v8, v6
    s_lshr_b32 s7, s2, 5
    s_mul_i32 s5, s7, 192
    s_add_u32 s22, s50, s5
    s_addc_u32 s23, s51, 0
    s_bfe_u32 s6, s2, 0x20003
    s_mul_i32 s6, s6, 0
    s_mov_b32 s24, 36
    s_mov_b32 s97, 4194304
LW_40:
    ds_read_b32 v2, v3 offset:36
    s_waitcnt lgkmcnt(0)
    v_readfirstlane_b32 s96, v2
    s_cmp_ge_u32 s96, 1
    s_cbranch_scc1 LWOK_41
    s_sleep 8
    s_sub_u32 s97, s97, 1
    s_cbranch_scc0 LW_40
LWOK_41:
M_WL:
    s_mul_i32 s5, s6, 3072
    s_mov_b32 m0, s5
    s_mul_i32 s5, s5, 6
    s_add_u32 s20, s22, s5
    s_addc_u32 s21, s23, 0
    global_load_lds_dwordx4 v20, s[20:21] offset:0
    global_load_lds_dwordx4 v21, s[20:21] offset:1024
    global_load_lds_dwordx4 v22, s[20:21] offset:2048
    s_add_u32 s6, s6, 1
    s_cmp_eq_u32 s6, 36
    s_cselect_b32 s6, 0, s6
    s_waitcnt vmcnt(6)
    s_sub_u32 s24, s24, 1
    s_cmp_lg_u32 s24, 0
    s_cbranch_scc1 M_WL
    v_min_u32 v9, 47, v0
    s_mul_i32 s5, s7, 6144
    s_add_u32 s5, s5, 14917632
    v_lshl_add_u32 v9, v9, 7, s5
    s_and_b32 s4, s2, 7
    s_lshl_b32 s4, s4, 2
    s_bfe_u32 s5, s2, 0x20003
    s_add_u32 s4, s4, s5
    s_lshl_b32 s5, s4, 10
    s_add_u32 s5, s5, 14884864
    v_and_b32 v10, 7, v0
    v_lshl_add_u32 v10, v10, 7, s5
    s_mov_b32 s97, 262144
FW_42:
    buffer_load_dword v12, v9, s[16:19], 0 offen sc1
    buffer_load_dword v13, v10, s[16:19], 0 offen sc1
    s_waitcnt vmcnt(0)
    v_xor_b32 v12, s74, v12
    v_xor_b32 v13, s74, v13
    v_or_b32 v12, v12, v13
    v_cmp_ne_u32 vcc, 0, v12
    s_cmp_eq_u64 vcc, 0
    s_cbranch_scc1 FWOK_43
    s_sleep 32
    s_sub_u32 s97, s97, 1
    s_cbranch_scc0 FW_42
FWOK_43:
    s_mul_i32 s5, s4, 73728
    s_mul_i32 s6, s7, 6144
    s_add_u32 s5, s5, s6
    s_add_u32 s5, s5, 12460032
    s_mov_b32 m0, 110592
    s_add_u32 s6, s5, 0
    buffer_load_dwordx4 v6, s[16:19], s6 offen offset:0 sc1 lds
    buffer_load_dwordx4 v6, s[16:19], s6 offen offset:1024 sc1 lds
    buffer_load_dwordx4 v6, s[16:19], s6 offen offset:2048 sc1 lds
    s_mov_b32 m0, 113664
    s_add_u32 s6, s5, 3072
    buffer_load_dwordx4 v6, s[16:19], s6 offen offset:0 sc1 lds
    buffer_load_dwordx4 v6, s[16:19], s6 offen offset:1024 sc1 lds
    buffer_load_dwordx4 v6, s[16:19], s6 offen offset:2048 sc1 lds
    s_mov_b32 m0, 116736
    s_add_u32 s6, s5, 36864
    buffer_load_dwordx4 v6, s[16:19], s6 offen offset:0 sc1 lds
    buffer_load_dwordx4 v6, s[16:19], s6 offen offset:1024 sc1 lds
    buffer_load_dwordx4 v6, s[16:19], s6 offen offset:2048 sc1 lds
    s_mov_b32 m0, 119808
    s_add_u32 s6, s5, 39936
    buffer_load_dwordx4 v6, s[16:19], s6 offen offset:0 sc1 lds
    buffer_load_dwordx4 v6, s[16:19], s6 offen offset:1024 sc1 lds
    buffer_load_dwordx4 v6, s[16:19], s6 offen offset:2048 sc1 lds
    s_mov_b32 m0, 122880
    s_lshl_b32 s5, s4, 9
    s_add_u32 s5, s5, 14819328
    s_mov_b32 exec_hi, 0
    buffer_load_dwordx4 v6, s[16:19], s5 offen sc1 lds
    s_mov_b64 exec, -1
    s_waitcnt vmcnt(0)
    s_mov_b64 exec, 1
    ds_add_u32 v3, v1 offset:108
    s_mov_b64 exec, -1
F_FIN:
F_END:
    s_endpgm
.section .rodata,"a"
.p2align 6
.amdhsa_kernel gated_mix__ssm_conv_s4d__mha_block__prompt_kernel
  .amdhsa_next_free_vgpr 168
  .amdhsa_next_free_sgpr 102
  .amdhsa_accum_offset 168
  .amdhsa_group_segment_fixed_size 0
  .amdhsa_kernarg_size 112
  .amdhsa_user_sgpr_count 2
  .amdhsa_user_sgpr_kernarg_segment_ptr 1
  .amdhsa_system_sgpr_workgroup_id_x 1
.end_amdhsa_kernel
```
